```python
import torch

def _softmax(x, axis=-1):
    return torch.softmax(x, dim=axis)
def _gelu(x):
    return torch.nn.functional.gelu(x, approximate="tanh")
def _silu(x):
    return torch.nn.functional.silu(x)
def _sigmoid(x):
    return torch.sigmoid(x)
def _layernorm(x, axis=-1, eps=1e-5):
    m = x.mean(dim=axis, keepdim=True)
    v = x.var(dim=axis, keepdim=True, unbiased=False)
    return (x - m) / torch.sqrt(v + eps)
def _scatter_add(tgt, idx, src, axis=0):
    return tgt.clone().index_add_(axis, idx, src)
def _segment_sum(src, seg, n):
    out = torch.zeros((n,) + src.shape[1:], dtype=src.dtype)
    return out.index_add_(0, seg, src)
def _pad(x, pw):
    flat = tuple(v for pair in reversed(pw) for v in pair)
    return torch.nn.functional.pad(x, flat)

kernel_name = 'interleave_layers__ssm_conv_h3__dense_activation_relu__prompt'

def setup_inputs():

    _w = (lambda a: (lambda t: t.to(torch.bfloat16) if t.is_floating_point() else t)(torch.as_tensor(a)))
    def _A_setup():
        B, S, D = 1, 2048, 448
        ks = 4
        return {
            "q": _w((lambda *s: torch.randn(*s, dtype=torch.bfloat16) * 0.05)(B, S, D)),
            "k": _w((lambda *s: torch.randn(*s, dtype=torch.bfloat16) * 0.8)(B, S, D)),
            "v": _w((lambda *s: torch.randn(*s, dtype=torch.bfloat16) * 0.8)(B, S, D)),
            "shift_k": _w((lambda *s: torch.randn(*s, dtype=torch.bfloat16) * 0.8)(D, ks) * 0.5),
            "ssm_k": _w((lambda *s: torch.randn(*s, dtype=torch.bfloat16) * 0.8)(D, S) * (1.0 / S ** 0.5)),
            "ssm_D": _w((lambda *s: torch.randn(*s, dtype=torch.bfloat16) * 0.8)(D)),
        }
    _A_in = _A_setup()

    def _B_setup():
        B, S, D, Dff = 1, 2048, 448, 1792
        return {
            "x": _w((lambda *s: torch.randn(*s, dtype=torch.bfloat16) * 0.05)(B, S, D)),
            "w1": _w((lambda *s: torch.randn(*s, dtype=torch.bfloat16) * 0.1)(D, Dff)),
            "w2": _w((lambda *s: torch.randn(*s, dtype=torch.bfloat16) * 0.1)(Dff, D)),
        }
    _B_in = _B_setup()

    return {
        "A_q": _A_in["q"],
        "A_k": _A_in["k"],
        "A_v": _A_in["v"],
        "A_shift_k": _A_in["shift_k"],
        "A_ssm_k": _A_in["ssm_k"],
        "A_ssm_D": _A_in["ssm_D"],
        "B_x": _B_in["x"],
        "B_w1": _B_in["w1"],
        "B_w2": _B_in["w2"],
    }

def reference(A_q, A_k, A_v, A_shift_k, A_ssm_k, A_ssm_D, B_x, B_w1, B_w2):
    def _A_ref(q, k, v, shift_k, ssm_k, ssm_D):
        B, S, D = q.shape
        ks = shift_k.shape[-1]
        k_pad = _pad(k, ((0, 0), (ks - 1, 0), (0, 0)))
        k_shift = torch.zeros_like(k)
        for t in range(ks):
            k_shift = k_shift + k_pad[:, t:t + S, :] * shift_k[:, ks - 1 - t][None, None, :]
        kv = k_shift * v
        L = 2 * S
        kv_pad = _pad(kv, ((0, 0), (0, S), (0, 0)))
        kf_pad = _pad(ssm_k, ((0, 0), (0, S)))
        kv_f = (lambda x, axes=(-2,-1): torch.fft.rfft2(x.float(), dim=axes))(kv_pad[:, None, :, :], axes=(1, 2))
        kf_f = (lambda x, axes=(-2,-1): torch.fft.rfft2(x.float(), dim=axes))(kf_pad[:, None, :], axes=(1, 2))
        kf_f = (lambda x, *d: x.permute(*d))(kf_f, 1, 2, 0)
        y_f = kv_f * kf_f[None, :, :, :]
        y = (lambda x, s, axes=(-2,-1): torch.fft.irfft2(x, s=s, dim=axes).to(torch.bfloat16))(y_f, (1, L), axes=(1, 2))[:, 0, :S, :]
        y = y + kv * ssm_D[None, None, :]
        return q * y

    def _B_ref(x, w1, w2):
        h = torch.einsum("bsd,df->bsf", x, w1)
        zero = torch.zeros_like(h)
        h = torch.maximum(h, zero)
        return torch.einsum("bsf,fd->bsd", h, w2)

    x = A_q
    x = x + _A_ref(_layernorm(x, axis=-1), A_k, A_v, A_shift_k, A_ssm_k, A_ssm_D)
    x = x + _B_ref(_layernorm(x, axis=-1), B_w1, B_w2)
    x = x + _A_ref(_layernorm(x, axis=-1), A_k, A_v, A_shift_k, A_ssm_k, A_ssm_D)
    x = x + _B_ref(_layernorm(x, axis=-1), B_w1, B_w2)
    return x
```

```asm
; @launch grid=(224,1,1) block=(256,1,1) lds=157312
.amdgcn_target "amdgcn-amd-amdhsa--gfx950"
.text
.globl interleave_layers__ssm_conv_h3__dense_activation_relu__prompt_kernel
.p2align 8
.type interleave_layers__ssm_conv_h3__dense_activation_relu__prompt_kernel,@function
interleave_layers__ssm_conv_h3__dense_activation_relu__prompt_kernel:
  s_load_dwordx16 s[16:31], s[0:1], 0
  s_load_dwordx8 s[32:39], s[0:1], 64
  s_cmp_ge_u32 s2, 224
  s_cbranch_scc1 MAIN_END
  s_getpc_b64 s[86:87]
PPF_PC:
  v_lshlrev_b32 v71, 7, v0
  global_load_dword v72, v71, s[86:87]
  v_add_u32 v71, 0x8000, v71
  v_cmp_gt_u32 vcc, MAIN_END-PPF_PC, v71
  s_nop 0
  s_and_saveexec_b64 s[78:79], vcc
  s_cbranch_execz PPF_S
  global_load_dword v72, v71, s[86:87]
PPF_S:
  s_mov_b64 exec, -1
  v_and_b32 v1, 63, v0
  v_lshrrev_b32 v2, 6, v0
  s_nop 0
  v_readfirstlane_b32 s3, v2
  s_mul_hi_u32 s6, s2, 0x24924925
  s_mul_i32 s7, s6, 7
  s_sub_u32 s7, s2, s7
  v_and_b32 v252, 7, v0
  v_lshrrev_b32 v253, 3, v0
  s_lshl_b32 s8, s6, 6
  v_lshl_add_u32 v254, v253, 1, s8
  s_movk_i32 s8, 896
  v_mul_lo_u32 v254, v254, s8
  s_lshl_b32 s8, s7, 7
  v_lshl_add_u32 v255, v252, 4, s8
  v_add_u32 v254, v254, v255
  v_add_u32 v44, -896, v254
  v_add_u32 v45, -1792, v254
  v_add_u32 v46, -2688, v254
  v_lshlrev_b32 v255, 2, v255
  v_lshlrev_b32 v2, 4, v1
  s_waitcnt lgkmcnt(0)
  s_mov_b32 s88, s22
  s_mov_b32 s89, s23
  s_mov_b32 s90, 0xe00
  s_mov_b32 s91, 0x20000
  s_mov_b32 s56, s18
  s_mov_b32 s57, s19
  s_mov_b32 s58, 0x1c0000
  s_mov_b32 s59, 0x20000
  s_mov_b32 s84, s20
  s_mov_b32 s85, s21
  s_mov_b32 s86, 0x1c0000
  s_mov_b32 s87, 0x20000
  buffer_load_dwordx4 v[136:139], v255, s[88:91], 0 offen offset:0
  buffer_load_dwordx4 v[140:143], v255, s[88:91], 0 offen offset:16
  buffer_load_dwordx4 v[144:147], v255, s[88:91], 0 offen offset:32
  buffer_load_dwordx4 v[148:151], v255, s[88:91], 0 offen offset:48
  buffer_load_dwordx4 v[152:155], v46, s[56:59], 0 offen
  buffer_load_dwordx4 v[156:159], v45, s[56:59], 0 offen
  buffer_load_dwordx4 v[160:163], v44, s[56:59], 0 offen
  buffer_load_dwordx4 v[164:167], v254, s[56:59], 0 offen
  buffer_load_dwordx4 v[168:171], v254, s[56:59], 0 offen offset:896
  buffer_load_dwordx4 v[172:175], v254, s[84:87], 0 offen
  buffer_load_dwordx4 v[176:179], v254, s[84:87], 0 offen offset:896
  s_mov_b32 s88, s36
  s_mov_b32 s89, s37
  s_mov_b32 s90, 0x100
  s_mov_b32 s91, 0x20000
  s_mov_b32 s40, s38
  s_mov_b32 s41, s39
  s_mov_b32 s42, 0x2000000
  s_mov_b32 s43, 0x20000
  v_mov_b32 v0, 0
  s_or_b32 s8, s2, s3
  s_cmp_lg_u32 s8, 0
  s_cbranch_scc1 PN_SKIP
  s_memrealtime s[8:9]
  s_waitcnt lgkmcnt(0)
  s_or_b32 s8, s8, 1
  v_mov_b32 v4, s8
  v_mov_b32 v5, 0
  s_mov_b64 exec, 1
  buffer_atomic_cmpswap v[4:5], v0, s[88:91], 0 offen sc1
  s_mov_b64 exec, -1
PN_SKIP:
  s_lshr_b32 s8, s3, 1
  s_and_b32 s9, s3, 1
  s_lshl_b32 s10, s2, 1
  s_add_u32 s10, s10, s8
  s_lshl_b32 s11, s10, 12
  s_mul_i32 s12, s8, 39936
  s_lshl_b32 s13, s9, 11
  v_add_u32 v251, s13, v2
  v_add_u32 v77, -16, v251
  s_add_u32 s44, s24, s11
  s_addc_u32 s45, s25, 0
  s_mov_b32 s46, 0x1000
  s_mov_b32 s47, 0x20000
  s_lshl_b32 s14, s2, 2
  s_load_dword s15, s[26:27], s14
  s_lshl_b32 s68, s7, 2
  s_add_u32 s68, s68, s3
  s_sub_u32 s69, 31, s6
  s_lshl_b32 s80, s68, 16
  s_lshl_b32 s70, s69, 7
  s_add_u32 s80, s80, s70
  s_lshl_b32 s81, s68, 5
  s_add_u32 s81, s81, s69
  s_lshl_b32 s81, s81, 3
  s_add_u32 s81, s81, 8388608
  v_lshrrev_b32 v250, 4, v1
  v_bfe_u32 v48, v1, 2, 2
  v_and_b32 v49, 3, v1
  v_lshl_add_u32 v50, v250, 3, v48
  v_mul_u32_u24 v50, 144, v50
  v_lshl_add_u32 v50, v49, 3, v50
  s_lshl_b32 s13, s3, 5
  s_add_u32 s13, s13, 79872
  v_add_u32 v50, s13, v50
  v_and_b32 v249, 15, v1
  s_lshl_b32 s58, s3, 13
  s_add_u32 s58, s58, 98304
  v_mul_u32_u24 v51, 144, v249
  v_lshl_add_u32 v51, v250, 4, v51
  v_add_u32 v51, s58, v51
  v_and_b32 v3, 7, v1
  v_lshrrev_b32 v6, 3, v1
  v_mul_u32_u24 v52, 144, v6
  v_lshl_add_u32 v52, v3, 4, v52
  v_add_u32 v52, s58, v52
  v_lshlrev_b32 v53, 12, v6
  v_lshl_add_u32 v53, v3, 4, v53
  v_lshlrev_b32 v54, 1, v253
  v_sub_u32 v54, 62, v54
  v_mul_u32_u24 v54, 144, v54
  v_lshl_add_u32 v54, v252, 4, v54
  v_add_u32 v54, 79872, v54
  s_mov_b32 s60, 0x00003f80
  s_mov_b32 s61, 0x3f800000
  s_mov_b32 s62, 0x3f803f80
  s_mov_b32 s63, 0x3b124925
  s_mov_b32 s64, 0xffff0000
  s_mov_b32 s65, 0xffff
  s_mov_b32 s83, 0
  s_mov_b32 s92, s30
  s_mov_b32 s93, s31
  s_mov_b32 s94, 0x188000
  s_mov_b32 s95, 0x20000
  s_mov_b32 s96, s32
  s_mov_b32 s97, s33
  s_mov_b32 s98, 0x188000
  s_mov_b32 s99, 0x20000
  s_mov_b32 s48, s16
  s_mov_b32 s49, s17
  s_mov_b32 s50, 0x1c0000
  s_mov_b32 s51, 0x20000
  s_lshl_b32 s84, s2, 2
  s_add_u32 s84, s84, s3
  v_bfe_u32 v55, v1, 4, 1
  v_lshlrev_b32 v55, 2, v55
  v_xor_b32 v55, v55, v3
  v_lshlrev_b32 v55, 4, v55
  s_movk_i32 s13, 3584
  v_mad_u32_u24 v56, v6, s13, v55
  s_movk_i32 s13, 896
  v_mad_u32_u24 v57, v6, s13, v55
  s_mul_hi_u32 s72, s84, 0x924924a
  s_mul_i32 s73, s72, 28
  s_sub_u32 s73, s84, s73
  s_mul_i32 s74, s72, 57344
  s_lshl_b32 s13, s73, 7
  s_add_u32 s74, s74, s13
  s_mul_i32 s75, s73, 56
  s_add_u32 s75, s75, s72
  s_lshl_b32 s75, s75, 10
  s_add_u32 s75, s75, 10485760
  s_mul_hi_u32 s72, s84, 0x24924925
  s_mul_i32 s73, s72, 7
  s_sub_u32 s73, s84, s73
  s_mul_i32 s76, s72, 14336
  s_lshl_b32 s13, s73, 7
  s_add_u32 s76, s76, s13
  s_mul_i32 s77, s73, 224
  s_add_u32 s77, s77, s72
  s_lshl_b32 s77, s77, 10
  s_add_u32 s77, s77, 12582912
  v_and_b32 v58, 1, v250
  v_lshlrev_b32 v58, 5, v58
  v_lshl_add_u32 v58, v49, 3, v58
  v_lshl_add_u32 v58, v48, 7, v58
  v_lshrrev_b32 v59, 1, v48
  v_lshlrev_b32 v59, 6, v59
  v_xor_b32 v60, 64, v59
  v_lshrrev_b32 v61, 1, v250
  v_lshl_add_u32 v62, v61, 10, v58
  v_lshl_add_u32 v63, v61, 9, v58
  v_add3_u32 v64, v62, v59, s58
  v_add3_u32 v65, v62, v60, s58
  v_add3_u32 v66, v63, v59, s58
  v_add3_u32 v67, v63, v60, s58
  v_add_u32 v68, s58, v2
  v_xor_b32 v69, v3, v6
  v_lshlrev_b32 v70, 4, v69
  s_movk_i32 s13, 896
  v_mad_u32_u24 v70, v6, s13, v70
  v_lshl_add_u32 v69, v3, 3, v69
  v_lshl_add_u32 v69, v69, 4, s58
  s_waitcnt vmcnt(7)
  v_and_b32 v80, s65, v136
  v_lshrrev_b32 v88, 16, v136
  v_and_b32 v96, s65, v137
  v_lshrrev_b32 v104, 16, v137
  v_lshlrev_b32 v81, 16, v138
  v_and_b32 v89, s64, v138
  v_lshlrev_b32 v97, 16, v139
  v_and_b32 v105, s64, v139
  v_and_b32 v82, s65, v140
  v_lshrrev_b32 v90, 16, v140
  v_and_b32 v98, s65, v141
  v_lshrrev_b32 v106, 16, v141
  v_lshlrev_b32 v83, 16, v142
  v_and_b32 v91, s64, v142
  v_lshlrev_b32 v99, 16, v143
  v_and_b32 v107, s64, v143
  v_and_b32 v84, s65, v144
  v_lshrrev_b32 v92, 16, v144
  v_and_b32 v100, s65, v145
  v_lshrrev_b32 v108, 16, v145
  v_lshlrev_b32 v85, 16, v146
  v_and_b32 v93, s64, v146
  v_lshlrev_b32 v101, 16, v147
  v_and_b32 v109, s64, v147
  v_and_b32 v86, s65, v148
  v_lshrrev_b32 v94, 16, v148
  v_and_b32 v102, s65, v149
  v_lshrrev_b32 v110, 16, v149
  v_lshlrev_b32 v87, 16, v150
  v_and_b32 v95, s64, v150
  v_lshlrev_b32 v103, 16, v151
  v_and_b32 v111, s64, v151
  s_waitcnt vmcnt(0)
  buffer_load_dword v252, v0, s[88:91], 0 offen sc1
  buffer_load_dwordx4 v[180:183], v77, s[44:47], 0 offen
  buffer_load_dwordx4 v[184:187], v251, s[44:47], 0 offen
  buffer_load_dwordx4 v[188:191], v251, s[44:47], 0 offen offset:1008
  buffer_load_dwordx4 v[192:195], v251, s[44:47], 0 offen offset:1024
  v_dot2_f32_bf16 v112, v152, v104, 0
  v_dot2_f32_bf16 v113, v152, v105, 0
  v_dot2_f32_bf16 v114, v153, v106, 0
  v_dot2_f32_bf16 v115, v153, v107, 0
  v_dot2_f32_bf16 v116, v154, v108, 0
  v_dot2_f32_bf16 v117, v154, v109, 0
  v_dot2_f32_bf16 v118, v155, v110, 0
  v_dot2_f32_bf16 v119, v155, v111, 0
  v_dot2_f32_bf16 v120, v156, v96, 0
  v_dot2_f32_bf16 v121, v156, v97, 0
  v_dot2_f32_bf16 v122, v157, v98, 0
  v_dot2_f32_bf16 v123, v157, v99, 0
  v_dot2_f32_bf16 v124, v158, v100, 0
  v_dot2_f32_bf16 v125, v158, v101, 0
  v_dot2_f32_bf16 v126, v159, v102, 0
  v_dot2_f32_bf16 v127, v159, v103, 0
  v_cvt_pk_bf16_f32 v112, v112, v120
  v_cvt_pk_bf16_f32 v113, v113, v121
  v_cvt_pk_bf16_f32 v114, v114, v122
  v_cvt_pk_bf16_f32 v115, v115, v123
  v_cvt_pk_bf16_f32 v116, v116, v124
  v_cvt_pk_bf16_f32 v117, v117, v125
  v_cvt_pk_bf16_f32 v118, v118, v126
  v_cvt_pk_bf16_f32 v119, v119, v127
  v_dot2_f32_bf16 v120, v160, v88, 0
  v_dot2_f32_bf16 v121, v160, v89, 0
  v_dot2_f32_bf16 v122, v161, v90, 0
  v_dot2_f32_bf16 v123, v161, v91, 0
  v_dot2_f32_bf16 v124, v162, v92, 0
  v_dot2_f32_bf16 v125, v162, v93, 0
  v_dot2_f32_bf16 v126, v163, v94, 0
  v_dot2_f32_bf16 v127, v163, v95, 0
  v_dot2_f32_bf16 v112, v112, s62, 0
  v_dot2_f32_bf16 v113, v113, s62, 0
  v_dot2_f32_bf16 v114, v114, s62, 0
  v_dot2_f32_bf16 v115, v115, s62, 0
  v_dot2_f32_bf16 v116, v116, s62, 0
  v_dot2_f32_bf16 v117, v117, s62, 0
  v_dot2_f32_bf16 v118, v118, s62, 0
  v_dot2_f32_bf16 v119, v119, s62, 0
  v_cvt_pk_bf16_f32 v112, v112, v120
  v_cvt_pk_bf16_f32 v113, v113, v121
  v_cvt_pk_bf16_f32 v114, v114, v122
  v_cvt_pk_bf16_f32 v115, v115, v123
  v_cvt_pk_bf16_f32 v116, v116, v124
  v_cvt_pk_bf16_f32 v117, v117, v125
  v_cvt_pk_bf16_f32 v118, v118, v126
  v_cvt_pk_bf16_f32 v119, v119, v127
  v_dot2_f32_bf16 v120, v164, v80, 0
  v_dot2_f32_bf16 v121, v164, v81, 0
  v_dot2_f32_bf16 v122, v165, v82, 0
  v_dot2_f32_bf16 v123, v165, v83, 0
  v_dot2_f32_bf16 v124, v166, v84, 0
  v_dot2_f32_bf16 v125, v166, v85, 0
  v_dot2_f32_bf16 v126, v167, v86, 0
  v_dot2_f32_bf16 v127, v167, v87, 0
  v_dot2_f32_bf16 v112, v112, s62, 0
  v_dot2_f32_bf16 v113, v113, s62, 0
  v_dot2_f32_bf16 v114, v114, s62, 0
  v_dot2_f32_bf16 v115, v115, s62, 0
  v_dot2_f32_bf16 v116, v116, s62, 0
  v_dot2_f32_bf16 v117, v117, s62, 0
  v_dot2_f32_bf16 v118, v118, s62, 0
  v_dot2_f32_bf16 v119, v119, s62, 0
  v_cvt_pk_bf16_f32 v112, v112, v120
  v_cvt_pk_bf16_f32 v113, v113, v121
  v_cvt_pk_bf16_f32 v114, v114, v122
  v_cvt_pk_bf16_f32 v115, v115, v123
  v_cvt_pk_bf16_f32 v116, v116, v124
  v_cvt_pk_bf16_f32 v117, v117, v125
  v_cvt_pk_bf16_f32 v118, v118, v126
  v_cvt_pk_bf16_f32 v119, v119, v127
  v_dot2_f32_bf16 v112, v112, s62, 0
  v_dot2_f32_bf16 v113, v113, s62, 0
  v_dot2_f32_bf16 v114, v114, s62, 0
  v_dot2_f32_bf16 v115, v115, s62, 0
  v_dot2_f32_bf16 v116, v116, s62, 0
  v_dot2_f32_bf16 v117, v117, s62, 0
  v_dot2_f32_bf16 v118, v118, s62, 0
  v_dot2_f32_bf16 v119, v119, s62, 0
  v_cvt_pk_bf16_f32 v120, v112, v113
  v_cvt_pk_bf16_f32 v121, v114, v115
  v_cvt_pk_bf16_f32 v122, v116, v117
  v_cvt_pk_bf16_f32 v123, v118, v119
  v_and_b32 v112, s65, v172
  v_and_b32 v113, s64, v172
  v_and_b32 v114, s65, v173
  v_and_b32 v115, s64, v173
  v_and_b32 v116, s65, v174
  v_and_b32 v117, s64, v174
  v_and_b32 v118, s65, v175
  v_and_b32 v119, s64, v175
  v_dot2_f32_bf16 v112, v120, v112, 0
  v_dot2_f32_bf16 v113, v120, v113, 0
  v_dot2_f32_bf16 v114, v121, v114, 0
  v_dot2_f32_bf16 v115, v121, v115, 0
  v_dot2_f32_bf16 v116, v122, v116, 0
  v_dot2_f32_bf16 v117, v122, v117, 0
  v_dot2_f32_bf16 v118, v123, v118, 0
  v_dot2_f32_bf16 v119, v123, v119, 0
  v_cvt_pk_bf16_f32 v128, v112, v113
  v_cvt_pk_bf16_f32 v129, v114, v115
  v_cvt_pk_bf16_f32 v130, v116, v117
  v_cvt_pk_bf16_f32 v131, v118, v119
  ds_write_b128 v54, v[128:131] offset:144
  v_dot2_f32_bf16 v112, v156, v104, 0
  v_dot2_f32_bf16 v113, v156, v105, 0
  v_dot2_f32_bf16 v114, v157, v106, 0
  v_dot2_f32_bf16 v115, v157, v107, 0
  v_dot2_f32_bf16 v116, v158, v108, 0
  v_dot2_f32_bf16 v117, v158, v109, 0
  v_dot2_f32_bf16 v118, v159, v110, 0
  v_dot2_f32_bf16 v119, v159, v111, 0
  v_dot2_f32_bf16 v120, v160, v96, 0
  v_dot2_f32_bf16 v121, v160, v97, 0
  v_dot2_f32_bf16 v122, v161, v98, 0
  v_dot2_f32_bf16 v123, v161, v99, 0
  v_dot2_f32_bf16 v124, v162, v100, 0
  v_dot2_f32_bf16 v125, v162, v101, 0
  v_dot2_f32_bf16 v126, v163, v102, 0
  v_dot2_f32_bf16 v127, v163, v103, 0
  v_cvt_pk_bf16_f32 v112, v112, v120
  v_cvt_pk_bf16_f32 v113, v113, v121
  v_cvt_pk_bf16_f32 v114, v114, v122
  v_cvt_pk_bf16_f32 v115, v115, v123
  v_cvt_pk_bf16_f32 v116, v116, v124
  v_cvt_pk_bf16_f32 v117, v117, v125
  v_cvt_pk_bf16_f32 v118, v118, v126
  v_cvt_pk_bf16_f32 v119, v119, v127
  v_dot2_f32_bf16 v120, v164, v88, 0
  v_dot2_f32_bf16 v121, v164, v89, 0
  v_dot2_f32_bf16 v122, v165, v90, 0
  v_dot2_f32_bf16 v123, v165, v91, 0
  v_dot2_f32_bf16 v124, v166, v92, 0
  v_dot2_f32_bf16 v125, v166, v93, 0
  v_dot2_f32_bf16 v126, v167, v94, 0
  v_dot2_f32_bf16 v127, v167, v95, 0
  v_dot2_f32_bf16 v112, v112, s62, 0
  v_dot2_f32_bf16 v113, v113, s62, 0
  v_dot2_f32_bf16 v114, v114, s62, 0
  v_dot2_f32_bf16 v115, v115, s62, 0
  v_dot2_f32_bf16 v116, v116, s62, 0
  v_dot2_f32_bf16 v117, v117, s62, 0
  v_dot2_f32_bf16 v118, v118, s62, 0
  v_dot2_f32_bf16 v119, v119, s62, 0
  v_cvt_pk_bf16_f32 v112, v112, v120
  v_cvt_pk_bf16_f32 v113, v113, v121
  v_cvt_pk_bf16_f32 v114, v114, v122
  v_cvt_pk_bf16_f32 v115, v115, v123
  v_cvt_pk_bf16_f32 v116, v116, v124
  v_cvt_pk_bf16_f32 v117, v117, v125
  v_cvt_pk_bf16_f32 v118, v118, v126
  v_cvt_pk_bf16_f32 v119, v119, v127
  v_dot2_f32_bf16 v120, v168, v80, 0
  v_dot2_f32_bf16 v121, v168, v81, 0
  v_dot2_f32_bf16 v122, v169, v82, 0
  v_dot2_f32_bf16 v123, v169, v83, 0
  v_dot2_f32_bf16 v124, v170, v84, 0
  v_dot2_f32_bf16 v125, v170, v85, 0
  v_dot2_f32_bf16 v126, v171, v86, 0
  v_dot2_f32_bf16 v127, v171, v87, 0
  v_dot2_f32_bf16 v112, v112, s62, 0
  v_dot2_f32_bf16 v113, v113, s62, 0
  v_dot2_f32_bf16 v114, v114, s62, 0
  v_dot2_f32_bf16 v115, v115, s62, 0
  v_dot2_f32_bf16 v116, v116, s62, 0
  v_dot2_f32_bf16 v117, v117, s62, 0
  v_dot2_f32_bf16 v118, v118, s62, 0
  v_dot2_f32_bf16 v119, v119, s62, 0
  v_cvt_pk_bf16_f32 v112, v112, v120
  v_cvt_pk_bf16_f32 v113, v113, v121
  v_cvt_pk_bf16_f32 v114, v114, v122
  v_cvt_pk_bf16_f32 v115, v115, v123
  v_cvt_pk_bf16_f32 v116, v116, v124
  v_cvt_pk_bf16_f32 v117, v117, v125
  v_cvt_pk_bf16_f32 v118, v118, v126
  v_cvt_pk_bf16_f32 v119, v119, v127
  v_dot2_f32_bf16 v112, v112, s62, 0
  v_dot2_f32_bf16 v113, v113, s62, 0
  v_dot2_f32_bf16 v114, v114, s62, 0
  v_dot2_f32_bf16 v115, v115, s62, 0
  v_dot2_f32_bf16 v116, v116, s62, 0
  v_dot2_f32_bf16 v117, v117, s62, 0
  v_dot2_f32_bf16 v118, v118, s62, 0
  v_dot2_f32_bf16 v119, v119, s62, 0
  v_cvt_pk_bf16_f32 v120, v112, v113
  v_cvt_pk_bf16_f32 v121, v114, v115
  v_cvt_pk_bf16_f32 v122, v116, v117
  v_cvt_pk_bf16_f32 v123, v118, v119
  v_and_b32 v112, s65, v176
  v_and_b32 v113, s64, v176
  v_and_b32 v114, s65, v177
  v_and_b32 v115, s64, v177
  v_and_b32 v116, s65, v178
  v_and_b32 v117, s64, v178
  v_and_b32 v118, s65, v179
  v_and_b32 v119, s64, v179
  v_dot2_f32_bf16 v112, v120, v112, 0
  v_dot2_f32_bf16 v113, v120, v113, 0
  v_dot2_f32_bf16 v114, v121, v114, 0
  v_dot2_f32_bf16 v115, v121, v115, 0
  v_dot2_f32_bf16 v116, v122, v116, 0
  v_dot2_f32_bf16 v117, v122, v117, 0
  v_dot2_f32_bf16 v118, v123, v118, 0
  v_dot2_f32_bf16 v119, v123, v119, 0
  v_cvt_pk_bf16_f32 v132, v112, v113
  v_cvt_pk_bf16_f32 v133, v114, v115
  v_cvt_pk_bf16_f32 v134, v116, v117
  v_cvt_pk_bf16_f32 v135, v118, v119
  ds_write_b128 v54, v[132:135] offset:0
  s_waitcnt lgkmcnt(0)
  s_barrier
  ds_read_b64_tr_b16 v[128:129], v50 offset:0
  ds_read_b64_tr_b16 v[130:131], v50 offset:576
  ds_read_b64_tr_b16 v[132:133], v50 offset:4608
  ds_read_b64_tr_b16 v[134:135], v50 offset:5184
  s_waitcnt lgkmcnt(2)
  ds_write_b128 v51, v[128:131] offset:0
  s_waitcnt lgkmcnt(1)
  ds_write_b128 v51, v[132:135] offset:64
  s_waitcnt lgkmcnt(0)
  ds_read_b128 v[128:131], v52 offset:0
  ds_read_b128 v[132:135], v52 offset:1152
  s_add_u32 s13, s80, 32768
  s_waitcnt lgkmcnt(1)
  buffer_store_dwordx4 v[128:131], v53, s[40:43], s80 offen sc1
  s_waitcnt lgkmcnt(0)
  buffer_store_dwordx4 v[132:135], v53, s[40:43], s13 offen sc1
  s_waitcnt vmcnt(6)
PN_P:
  v_readfirstlane_b32 s66, v252
  s_nop 0
  s_cmp_lg_u32 s66, 0
  s_cbranch_scc1 PN_D
  s_add_u32 s83, s83, 1
  s_cmp_gt_u32 s83, 0x40000
  s_cbranch_scc1 PN_D
  buffer_load_dword v252, v0, s[88:91], 0 offen sc1
  s_waitcnt vmcnt(0)
  s_branch PN_P
PN_D:
  s_not_b32 s67, s66
  v_mov_b32 v4, s66
  v_mov_b32 v5, s67
  s_waitcnt vmcnt(0)
  s_mov_b64 exec, 1
  buffer_store_dwordx2 v[4:5], v0, s[40:43], s81 offen sc1
  s_mov_b64 exec, -1
  s_add_u32 s13, s74, 28672
  buffer_load_dwordx4 v[216:219], v56, s[92:95], s74 offen
  buffer_load_dwordx4 v[220:223], v56, s[92:95], s13 offen
  s_add_u32 s13, s76, 7168
  buffer_load_dwordx4 v[224:227], v57, s[96:99], s76 offen
  buffer_load_dwordx4 v[228:231], v57, s[96:99], s13 offen
  v_add_u32 v246, s12, v251
  v_mov_b32 v236, 0
  v_mov_b32 v237, 0
  v_mov_b32 v238, 0
  v_mov_b32 v239, 0
  v_lshlrev_b32 v247, 2, v3
  s_mov_b32 s14, 0x1cb88541
  v_lshrrev_b32 v247, v247, s14
  v_and_b32 v247, 15, v247
  v_mul_u32_u24 v252, 272, v3
  v_add_u32 v247, v247, v252
  v_lshl_add_u32 v247, v247, 4, s12
  s_cmp_eq_u32 s9, 0
  s_cbranch_scc0 CV_Z1
  s_mov_b64 exec, 0xff
  ds_write_b128 v247, v[236:239]
  s_mov_b64 exec, -1
  s_branch CV_Z2
CV_Z1:
  v_add_u32 v252, s12, v2
  ds_write_b128 v252, v[236:239] offset:38912
CV_Z2:
  v_bfe_u32 v252, v1, 3, 1
  v_add_u32 v252, v252, v250
  v_lshl_add_u32 v247, v252, 4, v247
  s_lshl_b32 s14, s9, 8
  v_add_u32 v247, s14, v247
  v_lshlrev_b32 v248, 5, v249
  v_lshlrev_b32 v252, 4, v250
  v_sub_u32 v248, v252, v248
  s_add_u32 s14, s14, s12
  s_add_u32 s14, s14, 35296
  v_add_u32 v248, s14, v248
  v_mov_b32 v196, v181
  v_mov_b32 v197, v182
  v_mov_b32 v198, v183
  v_mov_b32 v199, v184
  v_mov_b32 v200, v185
  v_mov_b32 v201, v186
  v_alignbyte_b32 v202, v181, v180, 2
  v_alignbyte_b32 v203, v182, v181, 2
  v_alignbyte_b32 v204, v183, v182, 2
  v_alignbyte_b32 v205, v184, v183, 2
  v_alignbyte_b32 v206, v185, v184, 2
  v_alignbyte_b32 v207, v186, v185, 2
  v_alignbyte_b32 v208, v182, v181, 2
  v_alignbyte_b32 v209, v183, v182, 2
  v_alignbyte_b32 v210, v184, v183, 2
  v_alignbyte_b32 v211, v185, v184, 2
  v_alignbyte_b32 v212, v186, v185, 2
  v_alignbyte_b32 v213, v187, v186, 2
  ds_write_b128 v246, v[202:205] offset:32
  ds_write_b128 v246, v[196:199] offset:4432
  ds_write_b128 v246, v[208:211] offset:8800
  ds_write_b128 v246, v[182:185] offset:13200
  ds_write_b128 v246, v[204:207] offset:17552
  ds_write_b128 v246, v[198:201] offset:21952
  ds_write_b128 v246, v[210:213] offset:26320
  ds_write_b128 v246, v[184:187] offset:30496
  v_mov_b32 v80, v189
  v_mov_b32 v81, v190
  v_mov_b32 v82, v191
  v_mov_b32 v83, v192
  v_mov_b32 v84, v193
  v_mov_b32 v85, v194
  v_alignbyte_b32 v86, v189, v188, 2
  v_alignbyte_b32 v87, v190, v189, 2
  v_alignbyte_b32 v88, v191, v190, 2
  v_alignbyte_b32 v89, v192, v191, 2
  v_alignbyte_b32 v90, v193, v192, 2
  v_alignbyte_b32 v91, v194, v193, 2
  v_alignbyte_b32 v92, v190, v189, 2
  v_alignbyte_b32 v93, v191, v190, 2
  v_alignbyte_b32 v94, v192, v191, 2
  v_alignbyte_b32 v95, v193, v192, 2
  v_alignbyte_b32 v96, v194, v193, 2
  v_alignbyte_b32 v97, v195, v194, 2
  ds_write_b128 v246, v[86:89] offset:1056
  ds_write_b128 v246, v[80:83] offset:5456
  ds_write_b128 v246, v[92:95] offset:9824
  ds_write_b128 v246, v[190:193] offset:14224
  ds_write_b128 v246, v[88:91] offset:18576
  ds_write_b128 v246, v[82:85] offset:22976
  ds_write_b128 v246, v[94:97] offset:27344
  ds_write_b128 v246, v[192:195] offset:31520
  v_min_u32 v255, 15, v1
  v_lshlrev_b32 v255, 3, v255
  s_lshr_b32 s82, s10, 4
  s_lshl_b32 s82, s82, 8
  s_lshl_b32 s14, s9, 7
  s_add_u32 s82, s82, s14
  s_add_u32 s82, s82, 8388608
  buffer_load_dwordx2 v[128:129], v255, s[40:43], s82 offen sc1
  s_and_b32 s6, s2, 7
  s_lshr_b32 s7, s2, 3
  s_mul_hi_u32 s4, s7, 0x24924925
  s_mul_i32 s5, s4, 7
  s_sub_u32 s5, s7, s5
  s_lshl_b32 s6, s6, 2
  s_add_u32 s4, s4, s6
  s_lshl_b32 s71, s4, 3
  s_add_u32 s71, s71, s3
  s_lshl_b32 s73, s71, 6
  s_add_u32 s73, s73, 9961472
  s_mul_i32 s71, s71, 7168
  v_lshlrev_b32 v76, 3, v3
  s_lshl_b32 s56, s5, 3
  s_lshl_b32 s13, s3, 1
  s_add_u32 s56, s56, s13
  s_mul_i32 s56, s56, 28672
  s_add_u32 s56, s56, 10485760
  s_mul_i32 s57, s5, 224
  s_mul_i32 s13, s3, 28
  s_add_u32 s57, s57, s13
  s_lshl_b32 s57, s57, 10
  s_add_u32 s57, s57, 12582912
  s_lshl_b32 s59, s3, 11
  s_waitcnt vmcnt(0)
KFP:
  v_xor_b32 v128, s66, v128
  v_xor_b32 v129, s67, v129
  v_or_b32 v128, v128, v129
  v_cmp_ne_u32 vcc, 0, v128
  s_nop 0
  s_cbranch_vccz KFP_D
  s_add_u32 s83, s83, 1
  s_cmp_gt_u32 s83, 0x40000
  s_cbranch_scc1 KFP_D
  s_sleep 4
  buffer_load_dwordx2 v[128:129], v255, s[40:43], s82 offen sc1
  s_waitcnt vmcnt(0)
  s_branch KFP
KFP_D:
  buffer_load_dwordx4 v[128:131], v251, s[40:43], s11 offen sc1
  buffer_load_dwordx4 v[132:135], v251, s[40:43], s11 offen offset:1024 sc1
  ds_write_b128 v68, v[216:219] offset:4096
  ds_write_b128 v68, v[220:223] offset:5120
  ds_write_b128 v68, v[224:227] offset:6144
  ds_write_b128 v68, v[228:231] offset:7168
  s_waitcnt lgkmcnt(0)
  ds_read_b64_tr_b16 v[216:217], v64 offset:4096
  ds_read_b64_tr_b16 v[224:225], v66 offset:6144
  ds_read_b64_tr_b16 v[218:219], v64 offset:4608
  ds_read_b64_tr_b16 v[226:227], v66 offset:7168
  ds_read_b64_tr_b16 v[220:221], v65 offset:4096
  ds_read_b64_tr_b16 v[228:229], v67 offset:6144
  ds_read_b64_tr_b16 v[222:223], v65 offset:4608
  ds_read_b64_tr_b16 v[230:231], v67 offset:7168
  s_cmp_ge_u32 s84, 784
  s_cselect_b32 s75, 0x7ff00000, s75
  s_cselect_b32 s77, 0x7ff00000, s77
  s_add_u32 s13, s75, 28672
  s_add_u32 s14, s77, 114688
  s_waitcnt lgkmcnt(0)
  buffer_store_dwordx4 v[216:219], v2, s[40:43], s75 offen sc1
  buffer_store_dwordx4 v[220:223], v2, s[40:43], s13 offen sc1
  buffer_store_dwordx4 v[224:227], v2, s[40:43], s77 offen sc1
  buffer_store_dwordx4 v[228:231], v2, s[40:43], s14 offen sc1
  s_lshl_b32 s14, s84, 11
  buffer_load_dwordx4 v[16:19], v2, s[48:51], s14 offen
  buffer_load_dwordx4 v[20:23], v2, s[48:51], s14 offen offset:1024
  s_waitcnt vmcnt(7)
  ds_write_b128 v246, v[128:131] offset:34816
  s_waitcnt vmcnt(6)
  ds_write_b128 v246, v[132:135] offset:35840
  v_mov_b32 v254, v70
  v_mov_b32 v253, v69
  v_mov_b32 v79, v68
  v_min_u32 v252, 55, v1
  v_lshlrev_b32 v252, 4, v252
  s_waitcnt lgkmcnt(0)
  s_barrier
  s_add_u32 s72, s71, 28672
  ds_read_b128 v[112:115], v247 offset:0
  ds_read_b128 v[144:147], v248 offset:3584
  ds_read_b128 v[116:119], v247 offset:512
  ds_read_b128 v[148:151], v248 offset:3072
  ds_read_b128 v[120:123], v247 offset:1024
  ds_read_b128 v[152:155], v248 offset:2560
  ds_read_b128 v[124:127], v247 offset:1536
  ds_read_b128 v[156:159], v248 offset:2048
  ds_read_b128 v[128:131], v247 offset:2048
  ds_read_b128 v[160:163], v248 offset:1536
  ds_read_b128 v[132:135], v247 offset:2560
  ds_read_b128 v[164:167], v248 offset:1024
  ds_read_b128 v[136:139], v247 offset:3072
  ds_read_b128 v[168:171], v248 offset:512
  ds_read_b128 v[140:143], v247 offset:3584
  ds_read_b128 v[172:175], v248 offset:0
  s_waitcnt lgkmcnt(14)
  v_mfma_f32_16x16x32_bf16 v[80:83], v[112:115], v[144:147], 0
  s_waitcnt lgkmcnt(12)
  v_mfma_f32_16x16x32_bf16 v[84:87], v[112:115], v[148:151], 0
  v_mfma_f32_16x16x32_bf16 v[84:87], v[116:119], v[144:147], v[84:87]
  v_mfma_f32_16x16x32_bf16 v[88:91], v[116:119], v[148:151], 0
  s_waitcnt lgkmcnt(10)
  v_mfma_f32_16x16x32_bf16 v[88:91], v[112:115], v[152:155], v[88:91]
  ds_read_b128 v[176:179], v247 offset:64
  v_mfma_f32_16x16x32_bf16 v[92:95], v[116:119], v[152:155], 0
  ds_read_b128 v[208:211], v248 offset:3648
  v_mfma_f32_16x16x32_bf16 v[88:91], v[120:123], v[144:147], v[88:91]
  ds_read_b128 v[180:183], v247 offset:576
  v_mfma_f32_16x16x32_bf16 v[92:95], v[120:123], v[148:151], v[92:95]
  ds_read_b128 v[212:215], v248 offset:3136
  v_mfma_f32_16x16x32_bf16 v[96:99], v[120:123], v[152:155], 0
  ds_read_b128 v[184:187], v247 offset:1088
  s_waitcnt lgkmcnt(13)
  v_mfma_f32_16x16x32_bf16 v[92:95], v[112:115], v[156:159], v[92:95]
  ds_read_b128 v[216:219], v248 offset:2624
  v_mfma_f32_16x16x32_bf16 v[96:99], v[116:119], v[156:159], v[96:99]
  ds_read_b128 v[188:191], v247 offset:1600
  v_mfma_f32_16x16x32_bf16 v[100:103], v[120:123], v[156:159], 0
  ds_read_b128 v[220:223], v248 offset:2112
  v_mfma_f32_16x16x32_bf16 v[92:95], v[124:127], v[144:147], v[92:95]
  ds_read_b128 v[192:195], v247 offset:2112
  v_mfma_f32_16x16x32_bf16 v[96:99], v[124:127], v[148:151], v[96:99]
  ds_read_b128 v[224:227], v248 offset:1600
  v_mfma_f32_16x16x32_bf16 v[100:103], v[124:127], v[152:155], v[100:103]
  ds_read_b128 v[196:199], v247 offset:2624
  v_mfma_f32_16x16x32_bf16 v[104:107], v[124:127], v[156:159], 0
  ds_read_b128 v[228:231], v248 offset:1088
  s_waitcnt lgkmcnt(15)
  v_mfma_f32_16x16x32_bf16 v[96:99], v[112:115], v[160:163], v[96:99]
  ds_read_b128 v[200:203], v247 offset:3136
  v_mfma_f32_16x16x32_bf16 v[100:103], v[116:119], v[160:163], v[100:103]
  ds_read_b128 v[232:235], v248 offset:576
  v_mfma_f32_16x16x32_bf16 v[104:107], v[120:123], v[160:163], v[104:107]
  ds_read_b128 v[204:207], v247 offset:3648
  v_mfma_f32_16x16x32_bf16 v[108:111], v[124:127], v[160:163], 0
  ds_read_b128 v[236:239], v248 offset:64
  buffer_load_dwordx4 v[16:19], v254, s[48:51], s71 offen offset:0
  v_mfma_f32_16x16x32_bf16 v[96:99], v[128:131], v[144:147], v[96:99]
  v_mfma_f32_16x16x32_bf16 v[100:103], v[128:131], v[148:151], v[100:103]
  v_mfma_f32_16x16x32_bf16 v[104:107], v[128:131], v[152:155], v[104:107]
  v_mfma_f32_16x16x32_bf16 v[108:111], v[128:131], v[156:159], v[108:111]
  buffer_load_dwordx4 v[20:23], v254, s[48:51], s71 offen offset:128
  s_waitcnt lgkmcnt(15)
  v_mfma_f32_16x16x32_bf16 v[100:103], v[112:115], v[164:167], v[100:103]
  v_mfma_f32_16x16x32_bf16 v[104:107], v[116:119], v[164:167], v[104:107]
  v_mfma_f32_16x16x32_bf16 v[108:111], v[120:123], v[164:167], v[108:111]
  v_mfma_f32_16x16x32_bf16 v[100:103], v[132:135], v[144:147], v[100:103]
  buffer_load_dwordx4 v[24:27], v254, s[48:51], s71 offen offset:256
  v_mfma_f32_16x16x32_bf16 v[104:107], v[132:135], v[148:151], v[104:107]
  v_mfma_f32_16x16x32_bf16 v[108:111], v[132:135], v[152:155], v[108:111]
  s_waitcnt lgkmcnt(15)
  v_mfma_f32_16x16x32_bf16 v[104:107], v[112:115], v[168:171], v[104:107]
  v_mfma_f32_16x16x32_bf16 v[108:111], v[116:119], v[168:171], v[108:111]
  buffer_load_dwordx4 v[28:31], v254, s[48:51], s71 offen offset:384
  v_mfma_f32_16x16x32_bf16 v[104:107], v[136:139], v[144:147], v[104:107]
  v_mfma_f32_16x16x32_bf16 v[108:111], v[136:139], v[148:151], v[108:111]
  s_waitcnt lgkmcnt(15)
  v_mfma_f32_16x16x32_bf16 v[108:111], v[112:115], v[172:175], v[108:111]
  v_mfma_f32_16x16x32_bf16 v[108:111], v[140:143], v[144:147], v[108:111]
  buffer_load_dwordx4 v[32:35], v254, s[48:51], s71 offen offset:512
  s_waitcnt lgkmcnt(14)
  v_mfma_f32_16x16x32_bf16 v[80:83], v[176:179], v[208:211], v[80:83]
  s_waitcnt lgkmcnt(12)
  v_mfma_f32_16x16x32_bf16 v[84:87], v[176:179], v[212:215], v[84:87]
  v_mfma_f32_16x16x32_bf16 v[84:87], v[180:183], v[208:211], v[84:87]
  v_mfma_f32_16x16x32_bf16 v[88:91], v[180:183], v[212:215], v[88:91]
  buffer_load_dwordx4 v[36:39], v254, s[48:51], s71 offen offset:640
  s_waitcnt lgkmcnt(10)
  v_mfma_f32_16x16x32_bf16 v[88:91], v[176:179], v[216:219], v[88:91]
  ds_read_b128 v[112:115], v247 offset:128
  v_mfma_f32_16x16x32_bf16 v[92:95], v[180:183], v[216:219], v[92:95]
  ds_read_b128 v[144:147], v248 offset:3712
  v_mfma_f32_16x16x32_bf16 v[88:91], v[184:187], v[208:211], v[88:91]
  ds_read_b128 v[116:119], v247 offset:640
  v_mfma_f32_16x16x32_bf16 v[92:95], v[184:187], v[212:215], v[92:95]
  ds_read_b128 v[148:151], v248 offset:3200
  buffer_load_dwordx4 v[40:43], v254, s[48:51], s71 offen offset:768
  v_mfma_f32_16x16x32_bf16 v[96:99], v[184:187], v[216:219], v[96:99]
  ds_read_b128 v[120:123], v247 offset:1152
  s_waitcnt lgkmcnt(13)
  v_mfma_f32_16x16x32_bf16 v[92:95], v[176:179], v[220:223], v[92:95]
  ds_read_b128 v[152:155], v248 offset:2688
  v_mfma_f32_16x16x32_bf16 v[96:99], v[180:183], v[220:223], v[96:99]
  ds_read_b128 v[124:127], v247 offset:1664
  v_mfma_f32_16x16x32_bf16 v[100:103], v[184:187], v[220:223], v[100:103]
  ds_read_b128 v[156:159], v248 offset:2176
  buffer_load_dwordx4 v[48:51], v254, s[48:51], s72 offen offset:0
  v_mfma_f32_16x16x32_bf16 v[92:95], v[188:191], v[208:211], v[92:95]
  ds_read_b128 v[128:131], v247 offset:2176
  v_mfma_f32_16x16x32_bf16 v[96:99], v[188:191], v[212:215], v[96:99]
  ds_read_b128 v[160:163], v248 offset:1664
  v_mfma_f32_16x16x32_bf16 v[100:103], v[188:191], v[216:219], v[100:103]
  ds_read_b128 v[132:135], v247 offset:2688
  v_mfma_f32_16x16x32_bf16 v[104:107], v[188:191], v[220:223], v[104:107]
  ds_read_b128 v[164:167], v248 offset:1152
  buffer_load_dwordx4 v[52:55], v254, s[48:51], s72 offen offset:128
  s_waitcnt lgkmcnt(15)
  v_mfma_f32_16x16x32_bf16 v[96:99], v[176:179], v[224:227], v[96:99]
  ds_read_b128 v[136:139], v247 offset:3200
  v_mfma_f32_16x16x32_bf16 v[100:103], v[180:183], v[224:227], v[100:103]
  ds_read_b128 v[168:171], v248 offset:640
  v_mfma_f32_16x16x32_bf16 v[104:107], v[184:187], v[224:227], v[104:107]
  ds_read_b128 v[140:143], v247 offset:3712
  v_mfma_f32_16x16x32_bf16 v[108:111], v[188:191], v[224:227], v[108:111]
  ds_read_b128 v[172:175], v248 offset:128
  v_mfma_f32_16x16x32_bf16 v[96:99], v[192:195], v[208:211], v[96:99]
  v_mfma_f32_16x16x32_bf16 v[100:103], v[192:195], v[212:215], v[100:103]
  v_mfma_f32_16x16x32_bf16 v[104:107], v[192:195], v[216:219], v[104:107]
  v_mfma_f32_16x16x32_bf16 v[108:111], v[192:195], v[220:223], v[108:111]
  s_waitcnt lgkmcnt(15)
  v_mfma_f32_16x16x32_bf16 v[100:103], v[176:179], v[228:231], v[100:103]
  v_mfma_f32_16x16x32_bf16 v[104:107], v[180:183], v[228:231], v[104:107]
  v_mfma_f32_16x16x32_bf16 v[108:111], v[184:187], v[228:231], v[108:111]
  v_mfma_f32_16x16x32_bf16 v[100:103], v[196:199], v[208:211], v[100:103]
  v_mfma_f32_16x16x32_bf16 v[104:107], v[196:199], v[212:215], v[104:107]
  v_mfma_f32_16x16x32_bf16 v[108:111], v[196:199], v[216:219], v[108:111]
  s_waitcnt lgkmcnt(15)
  v_mfma_f32_16x16x32_bf16 v[104:107], v[176:179], v[232:235], v[104:107]
  v_mfma_f32_16x16x32_bf16 v[108:111], v[180:183], v[232:235], v[108:111]
  v_mfma_f32_16x16x32_bf16 v[104:107], v[200:203], v[208:211], v[104:107]
  v_mfma_f32_16x16x32_bf16 v[108:111], v[200:203], v[212:215], v[108:111]
  s_waitcnt lgkmcnt(15)
  v_mfma_f32_16x16x32_bf16 v[108:111], v[176:179], v[236:239], v[108:111]
  v_mfma_f32_16x16x32_bf16 v[108:111], v[204:207], v[208:211], v[108:111]
  s_waitcnt lgkmcnt(14)
  v_mfma_f32_16x16x32_bf16 v[80:83], v[112:115], v[144:147], v[80:83]
  s_waitcnt lgkmcnt(12)
  v_mfma_f32_16x16x32_bf16 v[84:87], v[112:115], v[148:151], v[84:87]
  v_mfma_f32_16x16x32_bf16 v[84:87], v[116:119], v[144:147], v[84:87]
  v_mfma_f32_16x16x32_bf16 v[88:91], v[116:119], v[148:151], v[88:91]
  s_waitcnt lgkmcnt(10)
  v_mfma_f32_16x16x32_bf16 v[88:91], v[112:115], v[152:155], v[88:91]
  ds_read_b128 v[176:179], v247 offset:192
  v_mfma_f32_16x16x32_bf16 v[92:95], v[116:119], v[152:155], v[92:95]
  ds_read_b128 v[208:211], v248 offset:3776
  v_mfma_f32_16x16x32_bf16 v[88:91], v[120:123], v[144:147], v[88:91]
  ds_read_b128 v[180:183], v247 offset:704
  v_mfma_f32_16x16x32_bf16 v[92:95], v[120:123], v[148:151], v[92:95]
  ds_read_b128 v[212:215], v248 offset:3264
  v_mfma_f32_16x16x32_bf16 v[96:99], v[120:123], v[152:155], v[96:99]
  ds_read_b128 v[184:187], v247 offset:1216
  s_waitcnt lgkmcnt(13)
  v_mfma_f32_16x16x32_bf16 v[92:95], v[112:115], v[156:159], v[92:95]
  ds_read_b128 v[216:219], v248 offset:2752
  v_mfma_f32_16x16x32_bf16 v[96:99], v[116:119], v[156:159], v[96:99]
  ds_read_b128 v[188:191], v247 offset:1728
  v_mfma_f32_16x16x32_bf16 v[100:103], v[120:123], v[156:159], v[100:103]
  ds_read_b128 v[220:223], v248 offset:2240
  v_mfma_f32_16x16x32_bf16 v[92:95], v[124:127], v[144:147], v[92:95]
  ds_read_b128 v[192:195], v247 offset:2240
  v_mfma_f32_16x16x32_bf16 v[96:99], v[124:127], v[148:151], v[96:99]
  ds_read_b128 v[224:227], v248 offset:1728
  v_mfma_f32_16x16x32_bf16 v[100:103], v[124:127], v[152:155], v[100:103]
  ds_read_b128 v[196:199], v247 offset:2752
  v_mfma_f32_16x16x32_bf16 v[104:107], v[124:127], v[156:159], v[104:107]
  ds_read_b128 v[228:231], v248 offset:1216
  s_waitcnt lgkmcnt(15)
  v_mfma_f32_16x16x32_bf16 v[96:99], v[112:115], v[160:163], v[96:99]
  ds_read_b128 v[200:203], v247 offset:3264
  v_mfma_f32_16x16x32_bf16 v[100:103], v[116:119], v[160:163], v[100:103]
  ds_read_b128 v[232:235], v248 offset:704
  v_mfma_f32_16x16x32_bf16 v[104:107], v[120:123], v[160:163], v[104:107]
  ds_read_b128 v[204:207], v247 offset:3776
  v_mfma_f32_16x16x32_bf16 v[108:111], v[124:127], v[160:163], v[108:111]
  ds_read_b128 v[236:239], v248 offset:192
  v_mfma_f32_16x16x32_bf16 v[96:99], v[128:131], v[144:147], v[96:99]
  v_mfma_f32_16x16x32_bf16 v[100:103], v[128:131], v[148:151], v[100:103]
  v_mfma_f32_16x16x32_bf16 v[104:107], v[128:131], v[152:155], v[104:107]
  v_mfma_f32_16x16x32_bf16 v[108:111], v[128:131], v[156:159], v[108:111]
  s_waitcnt lgkmcnt(15)
  v_mfma_f32_16x16x32_bf16 v[100:103], v[112:115], v[164:167], v[100:103]
  v_mfma_f32_16x16x32_bf16 v[104:107], v[116:119], v[164:167], v[104:107]
  v_mfma_f32_16x16x32_bf16 v[108:111], v[120:123], v[164:167], v[108:111]
  v_mfma_f32_16x16x32_bf16 v[100:103], v[132:135], v[144:147], v[100:103]
  v_mfma_f32_16x16x32_bf16 v[104:107], v[132:135], v[148:151], v[104:107]
  v_mfma_f32_16x16x32_bf16 v[108:111], v[132:135], v[152:155], v[108:111]
  s_waitcnt lgkmcnt(15)
  v_mfma_f32_16x16x32_bf16 v[104:107], v[112:115], v[168:171], v[104:107]
  v_mfma_f32_16x16x32_bf16 v[108:111], v[116:119], v[168:171], v[108:111]
  v_mfma_f32_16x16x32_bf16 v[104:107], v[136:139], v[144:147], v[104:107]
  v_mfma_f32_16x16x32_bf16 v[108:111], v[136:139], v[148:151], v[108:111]
  s_waitcnt lgkmcnt(15)
  v_mfma_f32_16x16x32_bf16 v[108:111], v[112:115], v[172:175], v[108:111]
  v_mfma_f32_16x16x32_bf16 v[108:111], v[140:143], v[144:147], v[108:111]
  s_waitcnt lgkmcnt(14)
  v_mfma_f32_16x16x32_bf16 v[80:83], v[176:179], v[208:211], v[80:83]
  s_waitcnt lgkmcnt(12)
  v_mfma_f32_16x16x32_bf16 v[84:87], v[176:179], v[212:215], v[84:87]
  v_mfma_f32_16x16x32_bf16 v[84:87], v[180:183], v[208:211], v[84:87]
  v_mfma_f32_16x16x32_bf16 v[88:91], v[180:183], v[212:215], v[88:91]
  s_waitcnt vmcnt(11)
  s_barrier
  s_lshl_b32 s81, s2, 3
  s_add_u32 s81, s81, 8400896
  s_cmp_lg_u32 s3, 0
  s_cselect_b32 s81, 0x7ff00000, s81
  s_mov_b64 exec, 1
  buffer_store_dwordx2 v[4:5], v0, s[40:43], s81 offen sc1
  s_mov_b64 exec, -1
  s_waitcnt lgkmcnt(10)
  v_mfma_f32_16x16x32_bf16 v[88:91], v[176:179], v[216:219], v[88:91]
  v_mfma_f32_16x16x32_bf16 v[92:95], v[180:183], v[216:219], v[92:95]
  v_mfma_f32_16x16x32_bf16 v[88:91], v[184:187], v[208:211], v[88:91]
  v_mfma_f32_16x16x32_bf16 v[92:95], v[184:187], v[212:215], v[92:95]
  v_mfma_f32_16x16x32_bf16 v[96:99], v[184:187], v[216:219], v[96:99]
  s_waitcnt lgkmcnt(8)
  v_mfma_f32_16x16x32_bf16 v[92:95], v[176:179], v[220:223], v[92:95]
  v_mfma_f32_16x16x32_bf16 v[96:99], v[180:183], v[220:223], v[96:99]
  v_mfma_f32_16x16x32_bf16 v[100:103], v[184:187], v[220:223], v[100:103]
  v_mfma_f32_16x16x32_bf16 v[92:95], v[188:191], v[208:211], v[92:95]
  v_mfma_f32_16x16x32_bf16 v[96:99], v[188:191], v[212:215], v[96:99]
  v_mfma_f32_16x16x32_bf16 v[100:103], v[188:191], v[216:219], v[100:103]
  v_mfma_f32_16x16x32_bf16 v[104:107], v[188:191], v[220:223], v[104:107]
  s_waitcnt lgkmcnt(6)
  v_mfma_f32_16x16x32_bf16 v[96:99], v[176:179], v[224:227], v[96:99]
  v_mfma_f32_16x16x32_bf16 v[100:103], v[180:183], v[224:227], v[100:103]
  v_mfma_f32_16x16x32_bf16 v[104:107], v[184:187], v[224:227], v[104:107]
  v_mfma_f32_16x16x32_bf16 v[108:111], v[188:191], v[224:227], v[108:111]
  v_mfma_f32_16x16x32_bf16 v[96:99], v[192:195], v[208:211], v[96:99]
  v_mfma_f32_16x16x32_bf16 v[100:103], v[192:195], v[212:215], v[100:103]
  v_mfma_f32_16x16x32_bf16 v[104:107], v[192:195], v[216:219], v[104:107]
  v_mfma_f32_16x16x32_bf16 v[108:111], v[192:195], v[220:223], v[108:111]
  s_waitcnt lgkmcnt(4)
  v_mfma_f32_16x16x32_bf16 v[100:103], v[176:179], v[228:231], v[100:103]
  v_mfma_f32_16x16x32_bf16 v[104:107], v[180:183], v[228:231], v[104:107]
  v_mfma_f32_16x16x32_bf16 v[108:111], v[184:187], v[228:231], v[108:111]
  v_mfma_f32_16x16x32_bf16 v[100:103], v[196:199], v[208:211], v[100:103]
  v_mfma_f32_16x16x32_bf16 v[104:107], v[196:199], v[212:215], v[104:107]
  v_mfma_f32_16x16x32_bf16 v[108:111], v[196:199], v[216:219], v[108:111]
  s_waitcnt lgkmcnt(2)
  v_mfma_f32_16x16x32_bf16 v[104:107], v[176:179], v[232:235], v[104:107]
  v_mfma_f32_16x16x32_bf16 v[108:111], v[180:183], v[232:235], v[108:111]
  v_mfma_f32_16x16x32_bf16 v[104:107], v[200:203], v[208:211], v[104:107]
  v_mfma_f32_16x16x32_bf16 v[108:111], v[200:203], v[212:215], v[108:111]
  s_waitcnt lgkmcnt(0)
  v_mfma_f32_16x16x32_bf16 v[108:111], v[176:179], v[236:239], v[108:111]
  v_mfma_f32_16x16x32_bf16 v[108:111], v[204:207], v[208:211], v[108:111]
  s_lshl_b32 s14, s3, 12
  s_add_u32 s14, s14, 79872
  v_add_u32 v44, s14, v2
  s_xor_b32 s14, s3, 1
  s_lshl_b32 s14, s14, 12
  s_add_u32 s14, s14, 79872
  v_add_u32 v45, s14, v2
  s_cmp_eq_u32 s9, 0
  s_cbranch_scc0 CV_R1
  ds_write_b128 v44, v[96:99] offset:0
  ds_write_b128 v44, v[100:103] offset:1024
  ds_write_b128 v44, v[104:107] offset:2048
  ds_write_b128 v44, v[108:111] offset:3072
  s_branch CV_R2
CV_R1:
  ds_write_b128 v44, v[80:83] offset:0
  ds_write_b128 v44, v[84:87] offset:1024
  ds_write_b128 v44, v[88:91] offset:2048
  ds_write_b128 v44, v[92:95] offset:3072
  v_mov_b32 v80, v96
  v_mov_b32 v81, v97
  v_mov_b32 v82, v98
  v_mov_b32 v83, v99
  v_mov_b32 v84, v100
  v_mov_b32 v85, v101
  v_mov_b32 v86, v102
  v_mov_b32 v87, v103
  v_mov_b32 v88, v104
  v_mov_b32 v89, v105
  v_mov_b32 v90, v106
  v_mov_b32 v91, v107
  v_mov_b32 v92, v108
  v_mov_b32 v93, v109
  v_mov_b32 v94, v110
  v_mov_b32 v95, v111
CV_R2:
  v_lshlrev_b32 v46, 5, v249
  v_lshl_add_u32 v46, v250, 3, v46
  s_lshl_b32 s14, s9, 11
  s_sub_u32 s14, 37368, s14
  s_add_u32 s14, s14, s12
  v_sub_u32 v46, s14, v46
  ds_read_b64 v[128:129], v46 offset:1536
  ds_read_b64 v[130:131], v46 offset:1024
  ds_read_b64 v[132:133], v46 offset:512
  ds_read_b64 v[134:135], v46 offset:0
  s_lshl_b32 s14, s15, 16
  s_and_b32 s15, s15, 0xffff0000
  s_cmp_eq_u32 s8, 0
  s_cselect_b32 s15, s14, s15
  s_waitcnt lgkmcnt(0)
  s_barrier
  ds_read_b128 v[112:115], v45 offset:0
  ds_read_b128 v[116:119], v45 offset:1024
  ds_read_b128 v[120:123], v45 offset:2048
  ds_read_b128 v[124:127], v45 offset:3072
  s_lshl_b32 s14, s9, 11
  s_add_u32 s14, s14, s12
  v_lshlrev_b32 v46, 5, v249
  v_lshl_add_u32 v46, v250, 3, v46
  v_add_u32 v46, s14, v46
  v_add_u32 v44, s14, v2
  s_lshl_b32 s14, s9, 4
  v_add_u32 v47, s14, v6
  v_mul_u32_u24 v47, 448, v47
  v_add_u32 v47, s10, v47
  v_lshlrev_b32 v47, 7, v47
  v_lshl_add_u32 v47, v3, 4, v47
  s_waitcnt lgkmcnt(3)
  v_add_f32 v80, v80, v112
  v_add_f32 v81, v81, v113
  v_add_f32 v82, v82, v114
  v_add_f32 v83, v83, v115
  v_and_b32 v144, s64, v129
  v_lshlrev_b32 v145, 16, v129
  v_and_b32 v146, s64, v128
  v_lshlrev_b32 v147, 16, v128
  v_mul_f32 v144, s15, v144
  v_mul_f32 v145, s15, v145
  v_mul_f32 v146, s15, v146
  v_mul_f32 v147, s15, v147
  v_cvt_pk_bf16_f32 v144, v144, v80
  v_cvt_pk_bf16_f32 v145, v145, v81
  v_cvt_pk_bf16_f32 v146, v146, v82
  v_cvt_pk_bf16_f32 v147, v147, v83
  v_dot2_f32_bf16 v144, v144, s62, 0
  v_dot2_f32_bf16 v145, v145, s62, 0
  v_dot2_f32_bf16 v146, v146, s62, 0
  v_dot2_f32_bf16 v147, v147, s62, 0
  s_nop 0
  v_cvt_pk_bf16_f32 v148, v144, v145
  s_nop 0
  v_cvt_pk_bf16_f32 v149, v146, v147
  ds_write_b64 v46, v[148:149] offset:0
  s_waitcnt lgkmcnt(3)
  v_add_f32 v84, v84, v116
  v_add_f32 v85, v85, v117
  v_add_f32 v86, v86, v118
  v_add_f32 v87, v87, v119
  v_and_b32 v144, s64, v131
  v_lshlrev_b32 v145, 16, v131
  v_and_b32 v146, s64, v130
  v_lshlrev_b32 v147, 16, v130
  v_mul_f32 v144, s15, v144
  v_mul_f32 v145, s15, v145
  v_mul_f32 v146, s15, v146
  v_mul_f32 v147, s15, v147
  v_cvt_pk_bf16_f32 v144, v144, v84
  v_cvt_pk_bf16_f32 v145, v145, v85
  v_cvt_pk_bf16_f32 v146, v146, v86
  v_cvt_pk_bf16_f32 v147, v147, v87
  v_dot2_f32_bf16 v144, v144, s62, 0
  v_dot2_f32_bf16 v145, v145, s62, 0
  v_dot2_f32_bf16 v146, v146, s62, 0
  v_dot2_f32_bf16 v147, v147, s62, 0
  s_nop 0
  v_cvt_pk_bf16_f32 v150, v144, v145
  s_nop 0
  v_cvt_pk_bf16_f32 v151, v146, v147
  ds_write_b64 v46, v[150:151] offset:512
  s_waitcnt lgkmcnt(3)
  v_add_f32 v88, v88, v120
  v_add_f32 v89, v89, v121
  v_add_f32 v90, v90, v122
  v_add_f32 v91, v91, v123
  v_and_b32 v144, s64, v133
  v_lshlrev_b32 v145, 16, v133
  v_and_b32 v146, s64, v132
  v_lshlrev_b32 v147, 16, v132
  v_mul_f32 v144, s15, v144
  v_mul_f32 v145, s15, v145
  v_mul_f32 v146, s15, v146
  v_mul_f32 v147, s15, v147
  v_cvt_pk_bf16_f32 v144, v144, v88
  v_cvt_pk_bf16_f32 v145, v145, v89
  v_cvt_pk_bf16_f32 v146, v146, v90
  v_cvt_pk_bf16_f32 v147, v147, v91
  v_dot2_f32_bf16 v144, v144, s62, 0
  v_dot2_f32_bf16 v145, v145, s62, 0
  v_dot2_f32_bf16 v146, v146, s62, 0
  v_dot2_f32_bf16 v147, v147, s62, 0
  s_nop 0
  v_cvt_pk_bf16_f32 v152, v144, v145
  s_nop 0
  v_cvt_pk_bf16_f32 v153, v146, v147
  ds_write_b64 v46, v[152:153] offset:1024
  s_waitcnt lgkmcnt(3)
  v_add_f32 v92, v92, v124
  v_add_f32 v93, v93, v125
  v_add_f32 v94, v94, v126
  v_add_f32 v95, v95, v127
  v_and_b32 v144, s64, v135
  v_lshlrev_b32 v145, 16, v135
  v_and_b32 v146, s64, v134
  v_lshlrev_b32 v147, 16, v134
  v_mul_f32 v144, s15, v144
  v_mul_f32 v145, s15, v145
  v_mul_f32 v146, s15, v146
  v_mul_f32 v147, s15, v147
  v_cvt_pk_bf16_f32 v144, v144, v92
  v_cvt_pk_bf16_f32 v145, v145, v93
  v_cvt_pk_bf16_f32 v146, v146, v94
  v_cvt_pk_bf16_f32 v147, v147, v95
  v_dot2_f32_bf16 v144, v144, s62, 0
  v_dot2_f32_bf16 v145, v145, s62, 0
  v_dot2_f32_bf16 v146, v146, s62, 0
  v_dot2_f32_bf16 v147, v147, s62, 0
  s_nop 0
  v_cvt_pk_bf16_f32 v154, v144, v145
  s_nop 0
  v_cvt_pk_bf16_f32 v155, v146, v147
  ds_write_b64 v46, v[154:155] offset:1536
  s_waitcnt lgkmcnt(0)
  ds_read_b128 v[112:115], v44 offset:0
  ds_read_b128 v[116:119], v44 offset:1024
  s_waitcnt lgkmcnt(1)
  s_mov_b32 s14, 2097152
  buffer_store_dwordx4 v[112:115], v47, s[40:43], s14 offen sc1
  s_waitcnt lgkmcnt(0)
  s_mov_b32 s14, 2555904
  buffer_store_dwordx4 v[116:119], v47, s[40:43], s14 offen sc1
  v_add_u32 v136, s59, v2
  v_mov_b32 v137, v136
  v_min_u32 v145, 27, v1
  v_lshlrev_b32 v145, 3, v145
  v_lshrrev_b32 v146, 1, v6
  v_lshlrev_b32 v146, 10, v146
  v_and_b32 v147, 1, v6
  v_lshl_add_u32 v146, v147, 9, v146
  v_lshl_add_u32 v146, v3, 4, v146
  s_lshl_b32 s70, s3, 7
  s_add_u32 s70, s70, 98304
  v_add_u32 v146, s70, v146
  s_lshl_b32 s70, s3, 6
  s_add_u32 s70, s70, 156800
  v_lshl_add_u32 v147, v3, 3, s70
  v_add_u32 v148, 98304, v2
  s_lshl_b32 s70, s5, 2
  s_add_u32 s70, s70, s3
  s_lshl_b32 s70, s70, 10
  v_add_u32 v149, s70, v148
  v_and_b32 v150, 31, v1
  v_mul_u32_u24 v155, 896, v150
  v_lshlrev_b32 v150, 3, v150
  v_add_u32 v150, 156800, v150
  v_lshrrev_b32 v144, 5, v1
  s_lshl_b32 s70, s3, 8
  s_add_u32 s70, s70, 155776
  v_lshl_add_u32 v151, v144, 6, s70
  s_mul_i32 s70, s3, 6144
  v_add_u32 v153, s70, v148
  v_bfe_u32 v154, v1, 3, 2
  v_mul_u32_u24 v154, 7168, v154
  v_lshl_add_u32 v154, v3, 4, v154
  s_lshl_b32 s70, s3, 1
  v_add_u32 v144, s70, v144
  v_lshl_add_u32 v154, v144, 7, v154
  v_lshl_add_u32 v155, v144, 4, v155
  s_lshl_b32 s69, s4, 8
  s_add_u32 s69, s69, 8404992
  s_lshl_b32 s76, s5, 2
  s_add_u32 s76, s76, s3
  s_lshl_b32 s75, s76, 12
  s_lshl_b32 s76, s76, 3
  s_add_u32 s76, s76, s69
  s_mul_i32 s77, s4, 229376
  s_add_u32 s75, s75, s77
  s_mul_i32 s70, s3, 28672
  s_add_u32 s77, s77, s70
  s_mul_i32 s78, s4, 57344
  s_lshl_b32 s70, s5, 7
  s_add_u32 s79, s78, s70
  s_lshl_b32 s70, s5, 10
  s_add_u32 s78, s78, s70
  s_mov_b32 s52, s34
  s_mov_b32 s53, s35
  s_mov_b32 s54, 0x1c0000
  s_mov_b32 s55, 0x20000
  v_mul_u32_u24 v76, 7184, v3
  s_mul_i32 s70, s3, 1792
  v_add_u32 v76, s70, v76
  s_and_b32 s70, s3, 1
  s_lshl_b32 s70, s70, 2
  v_xor_b32 v77, s70, v6
  v_xor_b32 v78, 4, v77
  v_lshl_add_u32 v77, v77, 4, v76
  v_lshl_add_u32 v78, v78, 4, v76
  v_lshrrev_b32 v44, 4, v1
  v_bfe_u32 v45, v1, 1, 1
  v_lshl_add_u32 v45, v44, 1, v45
  v_lshlrev_b32 v45, 7, v45
  v_bfe_u32 v46, v1, 2, 2
  v_lshl_add_u32 v45, v46, 4, v45
  v_and_b32 v46, 1, v1
  v_lshl_add_u32 v45, v46, 3, v45
  s_mul_i32 s70, s3, 7184
  v_add_u32 v45, s70, v45
  v_and_b32 v44, 1, v44
  v_lshlrev_b32 v44, 6, v44
  v_add_u32 v128, v45, v44
  v_xor_b32 v44, 64, v44
  v_add_u32 v129, v45, v44
  v_min_u32 v47, 55, v1
  v_lshlrev_b32 v47, 4, v47
  v_lshlrev_b32 v144, 3, v1
  v_mov_b32 v152, v136
  v_mov_b32 v3, v137
  s_waitcnt vmcnt(0)
  s_waitcnt lgkmcnt(0)
  s_barrier
  s_mul_i32 s81, s9, 224
  s_add_u32 s81, s81, s2
  s_lshl_b32 s81, s81, 3
  s_add_u32 s81, s81, 8396800
  s_cmp_lg_u32 s8, 0
  s_cselect_b32 s81, 0x7ff00000, s81
  s_mov_b64 exec, 1
  buffer_store_dwordx2 v[4:5], v0, s[40:43], s81 offen sc1
  s_mov_b64 exec, -1
  s_mov_b32 s82, 8400896
  buffer_load_dwordx4 v[68:71], v252, s[40:43], s82 offen offset:0 sc1
  buffer_load_dwordx4 v[72:75], v252, s[40:43], s82 offen offset:896 sc1
  ds_write_b128 v79, v[16:19] offset:0
  ds_write_b128 v79, v[20:23] offset:1024
  ds_write_b128 v79, v[24:27] offset:2048
  ds_write_b128 v79, v[28:31] offset:3072
  ds_write_b128 v79, v[32:35] offset:4096
  ds_write_b128 v79, v[36:39] offset:5120
  ds_write_b128 v79, v[40:43] offset:6144
  s_waitcnt lgkmcnt(0)
  ds_read_b128 v[16:19], v253 offset:0
  ds_read_b128 v[20:23], v253 offset:1024
  ds_read_b128 v[24:27], v253 offset:2048
  ds_read_b128 v[28:31], v253 offset:3072
  ds_read_b128 v[32:35], v253 offset:4096
  ds_read_b128 v[36:39], v253 offset:5120
  ds_read_b128 v[40:43], v253 offset:6144
  s_waitcnt lgkmcnt(0)
  s_waitcnt vmcnt(0)
PFP:
  v_xor_b32 v68, s66, v68
  v_xor_b32 v69, s67, v69
  v_xor_b32 v70, s66, v70
  v_xor_b32 v71, s67, v71
  v_xor_b32 v72, s66, v72
  v_xor_b32 v73, s67, v73
  v_xor_b32 v74, s66, v74
  v_xor_b32 v75, s67, v75
  v_or3_b32 v68, v68, v69, v70
  v_or3_b32 v71, v71, v72, v73
  v_or3_b32 v68, v68, v74, v75
  v_or_b32 v68, v68, v71
  v_cmp_ne_u32 vcc, 0, v68
  s_nop 0
  s_cbranch_vccz PFP_D
  s_add_u32 s83, s83, 1
  s_cmp_gt_u32 s83, 0x40000
  s_cbranch_scc1 PFP_D
  s_sleep 4
  buffer_load_dwordx4 v[68:71], v252, s[40:43], s82 offen offset:0 sc1
  buffer_load_dwordx4 v[72:75], v252, s[40:43], s82 offen offset:896 sc1
  s_waitcnt vmcnt(0)
  s_branch PFP
PFP_D:
  buffer_load_dwordx4 v[56:59], v254, s[48:51], s72 offen offset:256
  buffer_load_dwordx4 v[60:63], v254, s[48:51], s72 offen offset:384
  buffer_load_dwordx4 v[64:67], v254, s[48:51], s72 offen offset:512
  buffer_load_dwordx4 v[68:71], v254, s[48:51], s72 offen offset:640
  buffer_load_dwordx4 v[72:75], v254, s[48:51], s72 offen offset:768
  s_add_u32 s13, s56, 0
  buffer_load_dwordx4 a[0:3], v2, s[40:43], s13 offen offset:0 sc1
  s_add_u32 s13, s56, 28672
  buffer_load_dwordx4 a[4:7], v2, s[40:43], s13 offen offset:0 sc1
  s_add_u32 s13, s56, 0
  buffer_load_dwordx4 a[8:11], v2, s[40:43], s13 offen offset:1024 sc1
  s_add_u32 s13, s56, 28672
  buffer_load_dwordx4 a[12:15], v2, s[40:43], s13 offen offset:1024 sc1
  s_add_u32 s13, s56, 0
  buffer_load_dwordx4 a[16:19], v2, s[40:43], s13 offen offset:2048 sc1
  s_add_u32 s13, s56, 28672
  buffer_load_dwordx4 a[20:23], v2, s[40:43], s13 offen offset:2048 sc1
  s_add_u32 s13, s56, 0
  buffer_load_dwordx4 a[24:27], v2, s[40:43], s13 offen offset:3072 sc1
  s_add_u32 s13, s56, 28672
  buffer_load_dwordx4 a[28:31], v2, s[40:43], s13 offen offset:3072 sc1
  s_add_u32 s13, s56, 4096
  buffer_load_dwordx4 a[32:35], v2, s[40:43], s13 offen offset:0 sc1
  s_add_u32 s13, s56, 32768
  buffer_load_dwordx4 a[36:39], v2, s[40:43], s13 offen offset:0 sc1
  s_add_u32 s13, s56, 4096
  buffer_load_dwordx4 a[40:43], v2, s[40:43], s13 offen offset:1024 sc1
  s_add_u32 s13, s56, 32768
  buffer_load_dwordx4 a[44:47], v2, s[40:43], s13 offen offset:1024 sc1
  s_add_u32 s13, s56, 4096
  buffer_load_dwordx4 a[48:51], v2, s[40:43], s13 offen offset:2048 sc1
  v_dot2_f32_bf16 v80, v16, s62, 0
  v_dot2_f32_bf16 v81, v17, s62, 0
  v_dot2_f32_bf16 v80, v18, s62, v80
  v_dot2_f32_bf16 v81, v19, s62, v81
  v_dot2_f32_bf16 v80, v20, s62, v80
  v_dot2_f32_bf16 v81, v21, s62, v81
  v_dot2_f32_bf16 v80, v22, s62, v80
  v_dot2_f32_bf16 v81, v23, s62, v81
  v_dot2_f32_bf16 v80, v24, s62, v80
  v_dot2_f32_bf16 v81, v25, s62, v81
  v_dot2_f32_bf16 v80, v26, s62, v80
  v_dot2_f32_bf16 v81, v27, s62, v81
  v_dot2_f32_bf16 v80, v28, s62, v80
  v_dot2_f32_bf16 v81, v29, s62, v81
  v_dot2_f32_bf16 v80, v30, s62, v80
  v_dot2_f32_bf16 v81, v31, s62, v81
  s_add_u32 s13, s56, 32768
  buffer_load_dwordx4 a[52:55], v2, s[40:43], s13 offen offset:2048 sc1
  v_dot2_f32_bf16 v80, v32, s62, v80
  v_dot2_f32_bf16 v81, v33, s62, v81
  v_dot2_f32_bf16 v80, v34, s62, v80
  v_dot2_f32_bf16 v81, v35, s62, v81
  v_dot2_f32_bf16 v80, v36, s62, v80
  v_dot2_f32_bf16 v81, v37, s62, v81
  v_dot2_f32_bf16 v80, v38, s62, v80
  v_dot2_f32_bf16 v81, v39, s62, v81
  v_dot2_f32_bf16 v80, v40, s62, v80
  v_dot2_f32_bf16 v81, v41, s62, v81
  v_dot2_f32_bf16 v80, v42, s62, v80
  v_dot2_f32_bf16 v81, v43, s62, v81
  s_nop 2
  v_add_f32 v80, v80, v81
  s_nop 1
  v_add_f32 v80, v80, v80 row_ror:8
  v_mov_b32 v81, v80
  s_nop 1
  v_permlane16_swap_b32 v80, v81
  s_add_u32 s13, s56, 4096
  buffer_load_dwordx4 a[56:59], v2, s[40:43], s13 offen offset:3072 sc1
  v_add_f32 v80, v80, v81
  v_mov_b32 v81, v80
  s_nop 1
  v_permlane32_swap_b32 v80, v81
  v_add_f32 v80, v80, v81
  v_mul_f32 v80, s63, v80
  v_cvt_pk_bf16_f32 v8, v80, v80
  v_lshlrev_b32 v8, 16, v8
  v_sub_f32 v82, v80, v8
  v_sub_f32 v9, 0, v8
  v_dot2_f32_bf16 v86, v16, s60, v9
  v_dot2_f32_bf16 v87, v16, s61, v9
  v_dot2_f32_bf16 v88, v17, s60, v9
  v_dot2_f32_bf16 v89, v17, s61, v9
  v_dot2_f32_bf16 v90, v18, s60, v9
  v_dot2_f32_bf16 v91, v18, s61, v9
  v_pk_fma_f32 v[84:85], v[86:87], v[86:87], 0
  s_add_u32 s13, s56, 32768
  buffer_load_dwordx4 a[60:63], v2, s[40:43], s13 offen offset:3072 sc1
  v_dot2_f32_bf16 v86, v19, s60, v9
  v_dot2_f32_bf16 v87, v19, s61, v9
  v_pk_fma_f32 v[84:85], v[88:89], v[88:89], v[84:85]
  v_dot2_f32_bf16 v88, v20, s60, v9
  v_dot2_f32_bf16 v89, v20, s61, v9
  v_pk_fma_f32 v[84:85], v[90:91], v[90:91], v[84:85]
  v_dot2_f32_bf16 v90, v21, s60, v9
  v_dot2_f32_bf16 v91, v21, s61, v9
  v_pk_fma_f32 v[84:85], v[86:87], v[86:87], v[84:85]
  v_dot2_f32_bf16 v86, v22, s60, v9
  v_dot2_f32_bf16 v87, v22, s61, v9
  v_pk_fma_f32 v[84:85], v[88:89], v[88:89], v[84:85]
  v_dot2_f32_bf16 v88, v23, s60, v9
  v_dot2_f32_bf16 v89, v23, s61, v9
  v_pk_fma_f32 v[84:85], v[90:91], v[90:91], v[84:85]
  v_dot2_f32_bf16 v90, v24, s60, v9
  s_add_u32 s13, s56, 8192
  buffer_load_dwordx4 a[64:67], v2, s[40:43], s13 offen offset:0 sc1
  v_dot2_f32_bf16 v91, v24, s61, v9
  v_pk_fma_f32 v[84:85], v[86:87], v[86:87], v[84:85]
  v_dot2_f32_bf16 v86, v25, s60, v9
  v_dot2_f32_bf16 v87, v25, s61, v9
  v_pk_fma_f32 v[84:85], v[88:89], v[88:89], v[84:85]
  v_dot2_f32_bf16 v88, v26, s60, v9
  v_dot2_f32_bf16 v89, v26, s61, v9
  v_pk_fma_f32 v[84:85], v[90:91], v[90:91], v[84:85]
  v_dot2_f32_bf16 v90, v27, s60, v9
  v_dot2_f32_bf16 v91, v27, s61, v9
  v_pk_fma_f32 v[84:85], v[86:87], v[86:87], v[84:85]
  v_dot2_f32_bf16 v86, v28, s60, v9
  v_dot2_f32_bf16 v87, v28, s61, v9
  v_pk_fma_f32 v[84:85], v[88:89], v[88:89], v[84:85]
  v_dot2_f32_bf16 v88, v29, s60, v9
  v_dot2_f32_bf16 v89, v29, s61, v9
  s_add_u32 s13, s56, 36864
  buffer_load_dwordx4 a[68:71], v2, s[40:43], s13 offen offset:0 sc1
  v_pk_fma_f32 v[84:85], v[90:91], v[90:91], v[84:85]
  v_dot2_f32_bf16 v90, v30, s60, v9
  v_dot2_f32_bf16 v91, v30, s61, v9
  v_pk_fma_f32 v[84:85], v[86:87], v[86:87], v[84:85]
  v_dot2_f32_bf16 v86, v31, s60, v9
  v_dot2_f32_bf16 v87, v31, s61, v9
  v_pk_fma_f32 v[84:85], v[88:89], v[88:89], v[84:85]
  v_dot2_f32_bf16 v88, v32, s60, v9
  v_dot2_f32_bf16 v89, v32, s61, v9
  v_pk_fma_f32 v[84:85], v[90:91], v[90:91], v[84:85]
  v_dot2_f32_bf16 v90, v33, s60, v9
  v_dot2_f32_bf16 v91, v33, s61, v9
  v_pk_fma_f32 v[84:85], v[86:87], v[86:87], v[84:85]
  v_dot2_f32_bf16 v86, v34, s60, v9
  v_dot2_f32_bf16 v87, v34, s61, v9
  v_pk_fma_f32 v[84:85], v[88:89], v[88:89], v[84:85]
  s_add_u32 s13, s56, 8192
  buffer_load_dwordx4 a[72:75], v2, s[40:43], s13 offen offset:1024 sc1
  v_dot2_f32_bf16 v88, v35, s60, v9
  v_dot2_f32_bf16 v89, v35, s61, v9
  v_pk_fma_f32 v[84:85], v[90:91], v[90:91], v[84:85]
  v_dot2_f32_bf16 v90, v36, s60, v9
  v_dot2_f32_bf16 v91, v36, s61, v9
  v_pk_fma_f32 v[84:85], v[86:87], v[86:87], v[84:85]
  v_dot2_f32_bf16 v86, v37, s60, v9
  v_dot2_f32_bf16 v87, v37, s61, v9
  v_pk_fma_f32 v[84:85], v[88:89], v[88:89], v[84:85]
  v_dot2_f32_bf16 v88, v38, s60, v9
  v_dot2_f32_bf16 v89, v38, s61, v9
  v_pk_fma_f32 v[84:85], v[90:91], v[90:91], v[84:85]
  v_dot2_f32_bf16 v90, v39, s60, v9
  v_dot2_f32_bf16 v91, v39, s61, v9
  v_pk_fma_f32 v[84:85], v[86:87], v[86:87], v[84:85]
  v_dot2_f32_bf16 v86, v40, s60, v9
  s_add_u32 s13, s56, 36864
  buffer_load_dwordx4 a[76:79], v2, s[40:43], s13 offen offset:1024 sc1
  v_dot2_f32_bf16 v87, v40, s61, v9
  v_pk_fma_f32 v[84:85], v[88:89], v[88:89], v[84:85]
  v_dot2_f32_bf16 v88, v41, s60, v9
  v_dot2_f32_bf16 v89, v41, s61, v9
  v_pk_fma_f32 v[84:85], v[90:91], v[90:91], v[84:85]
  v_dot2_f32_bf16 v90, v42, s60, v9
  v_dot2_f32_bf16 v91, v42, s61, v9
  v_pk_fma_f32 v[84:85], v[86:87], v[86:87], v[84:85]
  v_dot2_f32_bf16 v86, v43, s60, v9
  v_dot2_f32_bf16 v87, v43, s61, v9
  v_pk_fma_f32 v[84:85], v[88:89], v[88:89], v[84:85]
  v_pk_fma_f32 v[84:85], v[90:91], v[90:91], v[84:85]
  s_nop 0
  v_pk_fma_f32 v[84:85], v[86:87], v[86:87], v[84:85]
  v_add_f32 v80, v84, v85
  s_nop 1
  v_add_f32 v80, v80, v80 row_ror:8
  v_mov_b32 v81, v80
  s_add_u32 s13, s56, 8192
  buffer_load_dwordx4 a[80:83], v2, s[40:43], s13 offen offset:2048 sc1
  v_permlane16_swap_b32 v80, v81
  v_add_f32 v80, v80, v81
  v_mov_b32 v81, v80
  s_nop 1
  v_permlane32_swap_b32 v80, v81
  v_add_f32 v80, v80, v81
  v_mul_f32 v82, v82, v82
  v_fma_f32 v80, s63, v80, -v82
  v_max_f32 v80, 0, v80
  v_cvt_pk_bf16_f32 v80, v80, v80
  v_lshlrev_b32 v80, 16, v80
  v_add_f32 v80, 0x3727c5ac, v80
  v_cvt_pk_bf16_f32 v80, v80, v80
  v_lshlrev_b32 v80, 16, v80
  v_sqrt_f32 v80, v80
  s_nop 0
  v_cvt_pk_bf16_f32 v80, v80, v80
  v_lshlrev_b32 v80, 16, v80
  s_add_u32 s13, s56, 36864
  buffer_load_dwordx4 a[84:87], v2, s[40:43], s13 offen offset:2048 sc1
  v_rcp_f32 v10, v80
  s_nop 0
  v_mul_f32 v11, v9, v10
  s_lshr_b32 s82, s4, 4
  s_mul_i32 s82, s82, 1792
  s_add_u32 s82, s82, 8396800
  buffer_load_dwordx4 v[116:119], v47, s[40:43], s82 offen offset:0 sc1
  buffer_load_dwordx4 v[120:123], v47, s[40:43], s82 offen offset:896 sc1
  s_waitcnt vmcnt(24)
  ds_write_b128 v79, v[48:51] offset:0
  ds_write_b128 v79, v[52:55] offset:1024
  ds_write_b128 v79, v[56:59] offset:2048
  ds_write_b128 v79, v[60:63] offset:3072
  ds_write_b128 v79, v[64:67] offset:4096
  ds_write_b128 v79, v[68:71] offset:5120
  ds_write_b128 v79, v[72:75] offset:6144
  s_waitcnt lgkmcnt(0)
  ds_read_b128 v[48:51], v253 offset:0
  ds_read_b128 v[52:55], v253 offset:1024
  ds_read_b128 v[56:59], v253 offset:2048
  ds_read_b128 v[60:63], v253 offset:3072
  ds_read_b128 v[64:67], v253 offset:4096
  ds_read_b128 v[68:71], v253 offset:5120
  ds_read_b128 v[72:75], v253 offset:6144
  s_waitcnt lgkmcnt(0)
  v_dot2_f32_bf16 v80, v48, s62, 0
  v_dot2_f32_bf16 v81, v49, s62, 0
  v_dot2_f32_bf16 v80, v50, s62, v80
  v_dot2_f32_bf16 v81, v51, s62, v81
  v_dot2_f32_bf16 v80, v52, s62, v80
  v_dot2_f32_bf16 v81, v53, s62, v81
  v_dot2_f32_bf16 v80, v54, s62, v80
  v_dot2_f32_bf16 v81, v55, s62, v81
  v_dot2_f32_bf16 v80, v56, s62, v80
  v_dot2_f32_bf16 v81, v57, s62, v81
  v_dot2_f32_bf16 v80, v58, s62, v80
  v_dot2_f32_bf16 v81, v59, s62, v81
  v_dot2_f32_bf16 v80, v60, s62, v80
  v_dot2_f32_bf16 v81, v61, s62, v81
  v_dot2_f32_bf16 v80, v62, s62, v80
  v_dot2_f32_bf16 v81, v63, s62, v81
  v_dot2_f32_bf16 v80, v64, s62, v80
  v_dot2_f32_bf16 v81, v65, s62, v81
  v_dot2_f32_bf16 v80, v66, s62, v80
  v_dot2_f32_bf16 v81, v67, s62, v81
  v_dot2_f32_bf16 v80, v68, s62, v80
  v_dot2_f32_bf16 v81, v69, s62, v81
  v_dot2_f32_bf16 v80, v70, s62, v80
  v_dot2_f32_bf16 v81, v71, s62, v81
  v_dot2_f32_bf16 v80, v72, s62, v80
  v_dot2_f32_bf16 v81, v73, s62, v81
  v_dot2_f32_bf16 v80, v74, s62, v80
  v_dot2_f32_bf16 v81, v75, s62, v81
  s_nop 2
  v_add_f32 v80, v80, v81
  s_nop 1
  v_add_f32 v80, v80, v80 row_ror:8
  v_mov_b32 v81, v80
  s_nop 1
  v_permlane16_swap_b32 v80, v81
  v_add_f32 v80, v80, v81
  v_mov_b32 v81, v80
  s_nop 1
  v_permlane32_swap_b32 v80, v81
  v_add_f32 v80, v80, v81
  v_mul_f32 v80, s63, v80
  v_cvt_pk_bf16_f32 v12, v80, v80
  v_lshlrev_b32 v12, 16, v12
  v_sub_f32 v82, v80, v12
  v_sub_f32 v13, 0, v12
  v_dot2_f32_bf16 v86, v48, s60, v13
  v_dot2_f32_bf16 v87, v48, s61, v13
  v_dot2_f32_bf16 v88, v49, s60, v13
  v_dot2_f32_bf16 v89, v49, s61, v13
  v_dot2_f32_bf16 v90, v50, s60, v13
  v_dot2_f32_bf16 v91, v50, s61, v13
  v_pk_fma_f32 v[84:85], v[86:87], v[86:87], 0
  v_dot2_f32_bf16 v86, v51, s60, v13
  v_dot2_f32_bf16 v87, v51, s61, v13
  v_pk_fma_f32 v[84:85], v[88:89], v[88:89], v[84:85]
  v_dot2_f32_bf16 v88, v52, s60, v13
  v_dot2_f32_bf16 v89, v52, s61, v13
  v_pk_fma_f32 v[84:85], v[90:91], v[90:91], v[84:85]
  v_dot2_f32_bf16 v90, v53, s60, v13
  v_dot2_f32_bf16 v91, v53, s61, v13
  v_pk_fma_f32 v[84:85], v[86:87], v[86:87], v[84:85]
  v_dot2_f32_bf16 v86, v54, s60, v13
  v_dot2_f32_bf16 v87, v54, s61, v13
  v_pk_fma_f32 v[84:85], v[88:89], v[88:89], v[84:85]
  v_dot2_f32_bf16 v88, v55, s60, v13
  v_dot2_f32_bf16 v89, v55, s61, v13
  v_pk_fma_f32 v[84:85], v[90:91], v[90:91], v[84:85]
  v_dot2_f32_bf16 v90, v56, s60, v13
  v_dot2_f32_bf16 v91, v56, s61, v13
  v_pk_fma_f32 v[84:85], v[86:87], v[86:87], v[84:85]
  v_dot2_f32_bf16 v86, v57, s60, v13
  v_dot2_f32_bf16 v87, v57, s61, v13
  v_pk_fma_f32 v[84:85], v[88:89], v[88:89], v[84:85]
  v_dot2_f32_bf16 v88, v58, s60, v13
  v_dot2_f32_bf16 v89, v58, s61, v13
  v_pk_fma_f32 v[84:85], v[90:91], v[90:91], v[84:85]
  v_dot2_f32_bf16 v90, v59, s60, v13
  v_dot2_f32_bf16 v91, v59, s61, v13
  v_pk_fma_f32 v[84:85], v[86:87], v[86:87], v[84:85]
  v_dot2_f32_bf16 v86, v60, s60, v13
  v_dot2_f32_bf16 v87, v60, s61, v13
  v_pk_fma_f32 v[84:85], v[88:89], v[88:89], v[84:85]
  v_dot2_f32_bf16 v88, v61, s60, v13
  v_dot2_f32_bf16 v89, v61, s61, v13
  v_pk_fma_f32 v[84:85], v[90:91], v[90:91], v[84:85]
  v_dot2_f32_bf16 v90, v62, s60, v13
  v_dot2_f32_bf16 v91, v62, s61, v13
  v_pk_fma_f32 v[84:85], v[86:87], v[86:87], v[84:85]
  v_dot2_f32_bf16 v86, v63, s60, v13
  v_dot2_f32_bf16 v87, v63, s61, v13
  v_pk_fma_f32 v[84:85], v[88:89], v[88:89], v[84:85]
  v_dot2_f32_bf16 v88, v64, s60, v13
  v_dot2_f32_bf16 v89, v64, s61, v13
  v_pk_fma_f32 v[84:85], v[90:91], v[90:91], v[84:85]
  v_dot2_f32_bf16 v90, v65, s60, v13
  v_dot2_f32_bf16 v91, v65, s61, v13
  v_pk_fma_f32 v[84:85], v[86:87], v[86:87], v[84:85]
  v_dot2_f32_bf16 v86, v66, s60, v13
  v_dot2_f32_bf16 v87, v66, s61, v13
  v_pk_fma_f32 v[84:85], v[88:89], v[88:89], v[84:85]
  v_dot2_f32_bf16 v88, v67, s60, v13
  v_dot2_f32_bf16 v89, v67, s61, v13
  v_pk_fma_f32 v[84:85], v[90:91], v[90:91], v[84:85]
  v_dot2_f32_bf16 v90, v68, s60, v13
  v_dot2_f32_bf16 v91, v68, s61, v13
  v_pk_fma_f32 v[84:85], v[86:87], v[86:87], v[84:85]
  v_dot2_f32_bf16 v86, v69, s60, v13
  v_dot2_f32_bf16 v87, v69, s61, v13
  v_pk_fma_f32 v[84:85], v[88:89], v[88:89], v[84:85]
  v_dot2_f32_bf16 v88, v70, s60, v13
  v_dot2_f32_bf16 v89, v70, s61, v13
  v_pk_fma_f32 v[84:85], v[90:91], v[90:91], v[84:85]
  v_dot2_f32_bf16 v90, v71, s60, v13
  v_dot2_f32_bf16 v91, v71, s61, v13
  v_pk_fma_f32 v[84:85], v[86:87], v[86:87], v[84:85]
  v_dot2_f32_bf16 v86, v72, s60, v13
  v_dot2_f32_bf16 v87, v72, s61, v13
  v_pk_fma_f32 v[84:85], v[88:89], v[88:89], v[84:85]
  v_dot2_f32_bf16 v88, v73, s60, v13
  v_dot2_f32_bf16 v89, v73, s61, v13
  v_pk_fma_f32 v[84:85], v[90:91], v[90:91], v[84:85]
  v_dot2_f32_bf16 v90, v74, s60, v13
  v_dot2_f32_bf16 v91, v74, s61, v13
  v_pk_fma_f32 v[84:85], v[86:87], v[86:87], v[84:85]
  v_dot2_f32_bf16 v86, v75, s60, v13
  v_dot2_f32_bf16 v87, v75, s61, v13
  v_pk_fma_f32 v[84:85], v[88:89], v[88:89], v[84:85]
  v_pk_fma_f32 v[84:85], v[90:91], v[90:91], v[84:85]
  s_nop 0
  v_pk_fma_f32 v[84:85], v[86:87], v[86:87], v[84:85]
  v_add_f32 v80, v84, v85
  s_nop 1
  v_add_f32 v80, v80, v80 row_ror:8
  v_mov_b32 v81, v80
  s_nop 1
  v_permlane16_swap_b32 v80, v81
  v_add_f32 v80, v80, v81
  v_mov_b32 v81, v80
  s_nop 1
  v_permlane32_swap_b32 v80, v81
  v_add_f32 v80, v80, v81
  v_mul_f32 v82, v82, v82
  v_fma_f32 v80, s63, v80, -v82
  v_max_f32 v80, 0, v80
  v_cvt_pk_bf16_f32 v80, v80, v80
  v_lshlrev_b32 v80, 16, v80
  v_add_f32 v80, 0x3727c5ac, v80
  v_cvt_pk_bf16_f32 v80, v80, v80
  v_lshlrev_b32 v80, 16, v80
  v_sqrt_f32 v80, v80
  s_nop 0
  v_cvt_pk_bf16_f32 v80, v80, v80
  v_lshlrev_b32 v80, 16, v80
  v_rcp_f32 v14, v80
  s_nop 0
  v_mul_f32 v15, v13, v14
  s_waitcnt vmcnt(0)
CFP:
  v_xor_b32 v116, s66, v116
  v_xor_b32 v117, s67, v117
  v_xor_b32 v118, s66, v118
  v_xor_b32 v119, s67, v119
  v_xor_b32 v120, s66, v120
  v_xor_b32 v121, s67, v121
  v_xor_b32 v122, s66, v122
  v_xor_b32 v123, s67, v123
  v_or3_b32 v116, v116, v117, v118
  v_or3_b32 v119, v119, v120, v121
  v_or3_b32 v116, v116, v122, v123
  v_or_b32 v116, v116, v119
  v_cmp_ne_u32 vcc, 0, v116
  s_nop 0
  s_cbranch_vccz CFP_D
  s_add_u32 s83, s83, 1
  s_cmp_gt_u32 s83, 0x40000
  s_cbranch_scc1 CFP_D
  s_sleep 4
  buffer_load_dwordx4 v[116:119], v47, s[40:43], s82 offen offset:0 sc1
  buffer_load_dwordx4 v[120:123], v47, s[40:43], s82 offen offset:896 sc1
  s_waitcnt vmcnt(0)
  s_branch CFP
CFP_D:
  s_mul_i32 s70, s4, 57344
  s_mul_i32 s72, s3, 14336
  s_add_u32 s70, s70, s72
  s_add_u32 s70, s70, 2097152
  buffer_load_dwordx4 v[80:83], v2, s[40:43], s70 offen offset:0 sc1
  buffer_load_dwordx4 v[84:87], v2, s[40:43], s70 offen offset:1024 sc1
  buffer_load_dwordx4 v[88:91], v2, s[40:43], s70 offen offset:2048 sc1
  buffer_load_dwordx4 v[92:95], v2, s[40:43], s70 offen offset:3072 sc1
  s_add_u32 s70, s70, 4096
  buffer_load_dwordx4 v[96:99], v2, s[40:43], s70 offen offset:0 sc1
  buffer_load_dwordx4 v[100:103], v2, s[40:43], s70 offen offset:1024 sc1
  buffer_load_dwordx4 v[104:107], v2, s[40:43], s70 offen offset:2048 sc1
  buffer_load_dwordx4 v[108:111], v2, s[40:43], s70 offen offset:3072 sc1
  s_add_u32 s70, s70, 4096
  buffer_load_dwordx4 v[112:115], v2, s[40:43], s70 offen offset:0 sc1
  buffer_load_dwordx4 v[116:119], v2, s[40:43], s70 offen offset:1024 sc1
  buffer_load_dwordx4 v[120:123], v2, s[40:43], s70 offen offset:2048 sc1
  buffer_load_dwordx4 v[124:127], v2, s[40:43], s70 offen offset:3072 sc1
  s_add_u32 s70, s70, 4096
  buffer_load_dwordx4 v[132:135], v2, s[40:43], s70 offen offset:0 sc1
  buffer_load_dwordx4 v[140:143], v2, s[40:43], s70 offen offset:1024 sc1
  s_add_u32 s13, s56, 8192
  buffer_load_dwordx4 a[88:91], v2, s[40:43], s13 offen offset:3072 sc1
  s_add_u32 s13, s56, 36864
  buffer_load_dwordx4 a[92:95], v2, s[40:43], s13 offen offset:3072 sc1
  s_add_u32 s13, s56, 12288
  buffer_load_dwordx4 a[96:99], v2, s[40:43], s13 offen offset:0 sc1
  s_add_u32 s13, s56, 40960
  buffer_load_dwordx4 a[100:103], v2, s[40:43], s13 offen offset:0 sc1
  s_add_u32 s13, s56, 12288
  buffer_load_dwordx4 a[104:107], v2, s[40:43], s13 offen offset:1024 sc1
  s_add_u32 s13, s56, 40960
  buffer_load_dwordx4 a[108:111], v2, s[40:43], s13 offen offset:1024 sc1
  s_add_u32 s13, s56, 12288
  buffer_load_dwordx4 a[112:115], v2, s[40:43], s13 offen offset:2048 sc1
  s_add_u32 s13, s56, 40960
  buffer_load_dwordx4 a[116:119], v2, s[40:43], s13 offen offset:2048 sc1
  s_add_u32 s13, s56, 12288
  buffer_load_dwordx4 a[120:123], v2, s[40:43], s13 offen offset:3072 sc1
  s_add_u32 s13, s56, 40960
  buffer_load_dwordx4 a[124:127], v2, s[40:43], s13 offen offset:3072 sc1
  s_add_u32 s13, s56, 16384
  buffer_load_dwordx4 a[128:131], v2, s[40:43], s13 offen offset:0 sc1
  s_add_u32 s13, s56, 45056
  buffer_load_dwordx4 a[132:135], v2, s[40:43], s13 offen offset:0 sc1
  s_waitcnt vmcnt(25)
  ds_write_b128 v77, v[80:83] offset:0
  s_waitcnt vmcnt(24)
  ds_write_b128 v77, v[84:87] offset:128
  s_waitcnt vmcnt(23)
  ds_write_b128 v78, v[88:91] offset:256
  s_waitcnt vmcnt(22)
  ds_write_b128 v78, v[92:95] offset:384
  s_waitcnt vmcnt(21)
  ds_write_b128 v77, v[96:99] offset:512
  s_waitcnt vmcnt(20)
  ds_write_b128 v77, v[100:103] offset:640
  s_waitcnt vmcnt(19)
  ds_write_b128 v78, v[104:107] offset:768
  s_waitcnt vmcnt(18)
  ds_write_b128 v78, v[108:111] offset:896
  s_waitcnt vmcnt(17)
  ds_write_b128 v77, v[112:115] offset:1024
  s_waitcnt vmcnt(16)
  ds_write_b128 v77, v[116:119] offset:1152
  s_waitcnt vmcnt(15)
  ds_write_b128 v78, v[120:123] offset:1280
  s_waitcnt vmcnt(14)
  ds_write_b128 v78, v[124:127] offset:1408
  s_waitcnt vmcnt(13)
  ds_write_b128 v77, v[132:135] offset:1536
  s_waitcnt vmcnt(12)
  ds_write_b128 v77, v[140:143] offset:1664
  s_waitcnt lgkmcnt(0)
  s_barrier
  ds_read_b64_tr_b16 v[80:81], v128 offset:0
  ds_read_b64_tr_b16 v[82:83], v129 offset:0
  ds_read_b64_tr_b16 v[84:85], v128 offset:1024
  ds_read_b64_tr_b16 v[86:87], v129 offset:1024
  ds_read_b64_tr_b16 v[88:89], v128 offset:2048
  ds_read_b64_tr_b16 v[90:91], v129 offset:2048
  ds_read_b64_tr_b16 v[92:93], v128 offset:3072
  ds_read_b64_tr_b16 v[94:95], v129 offset:3072
  ds_read_b64_tr_b16 v[96:97], v128 offset:4096
  ds_read_b64_tr_b16 v[98:99], v129 offset:4096
  ds_read_b64_tr_b16 v[100:101], v128 offset:5120
  ds_read_b64_tr_b16 v[102:103], v129 offset:5120
  ds_read_b64_tr_b16 v[104:105], v128 offset:6144
  ds_read_b64_tr_b16 v[106:107], v129 offset:6144
  s_waitcnt lgkmcnt(0)
  v_mov_b32 v132, s62
  v_mov_b32 v133, s62
  v_mov_b32 v134, s62
  v_mov_b32 v135, s62
  s_nop 1
  v_mfma_f32_32x32x16_bf16 v[224:239], a[0:3], v[132:135], 0
  s_lshl_b32 s72, s5, 10
  s_add_u32 s72, s72, s71
  s_add_u32 s72, s72, 4194304
  s_cmp_lg_u32 s5, 0
  s_cbranch_scc1 P3_00_YX0
  buffer_store_dwordx4 v[80:83], v2, s[40:43], s72 offen sc1
P3_00_YX0:
  s_cmp_lg_u32 s5, 1
  s_cbranch_scc1 P3_00_YX1
  buffer_store_dwordx4 v[84:87], v2, s[40:43], s72 offen sc1
P3_00_YX1:
  s_cmp_lg_u32 s5, 2
  s_cbranch_scc1 P3_00_YX2
  buffer_store_dwordx4 v[88:91], v2, s[40:43], s72 offen sc1
P3_00_YX2:
  s_cmp_lg_u32 s5, 3
  s_cbranch_scc1 P3_00_YX3
  buffer_store_dwordx4 v[92:95], v2, s[40:43], s72 offen sc1
P3_00_YX3:
  s_cmp_lg_u32 s5, 4
  s_cbranch_scc1 P3_00_YX4
  buffer_store_dwordx4 v[96:99], v2, s[40:43], s72 offen sc1
P3_00_YX4:
  s_cmp_lg_u32 s5, 5
  s_cbranch_scc1 P3_00_YX5
  buffer_store_dwordx4 v[100:103], v2, s[40:43], s72 offen sc1
P3_00_YX5:
  s_cmp_lg_u32 s5, 6
  s_cbranch_scc1 P3_00_YX6
  buffer_store_dwordx4 v[104:107], v2, s[40:43], s72 offen sc1
P3_00_YX6:
  v_lshlrev_b32 v108, 16, v16
  v_and_b32 v109, s64, v16
  v_lshlrev_b32 v110, 16, v17
  v_and_b32 v111, s64, v17
  v_lshlrev_b32 v112, 16, v18
  v_and_b32 v113, s64, v18
  v_mfma_f32_32x32x16_bf16 v[240:255], a[4:7], v[132:135], 0
  v_lshlrev_b32 v114, 16, v19
  v_and_b32 v115, s64, v19
  v_fma_f32 v116, v108, v10, v11
  v_fma_f32 v117, v109, v10, v11
  v_fma_f32 v118, v110, v10, v11
  v_fma_f32 v119, v111, v10, v11
  v_lshlrev_b32 v120, 16, v80
  s_add_u32 s13, s56, 16384
  buffer_load_dwordx4 a[136:139], v2, s[40:43], s13 offen offset:1024 sc1
  v_mfma_f32_32x32x16_bf16 v[224:239], a[8:11], v[132:135], v[224:239]
  v_and_b32 v121, s64, v80
  v_lshlrev_b32 v122, 16, v81
  v_and_b32 v123, s64, v81
  v_fmac_f32 v108, v116, v120
  v_fmac_f32 v109, v117, v121
  v_fmac_f32 v110, v118, v122
  v_fmac_f32 v111, v119, v123
  v_mfma_f32_32x32x16_bf16 v[240:255], a[12:15], v[132:135], v[240:255]
  v_fma_f32 v116, v112, v10, v11
  v_fma_f32 v117, v113, v10, v11
  v_fma_f32 v118, v114, v10, v11
  v_fma_f32 v119, v115, v10, v11
  v_lshlrev_b32 v120, 16, v82
  v_and_b32 v121, s64, v82
  v_lshlrev_b32 v122, 16, v83
  s_add_u32 s13, s56, 45056
  buffer_load_dwordx4 a[140:143], v2, s[40:43], s13 offen offset:1024 sc1
  v_mfma_f32_32x32x16_bf16 v[224:239], a[16:19], v[132:135], v[224:239]
  v_and_b32 v123, s64, v83
  v_fmac_f32 v112, v116, v120
  v_fmac_f32 v113, v117, v121
  v_fmac_f32 v114, v118, v122
  v_fmac_f32 v115, v119, v123
  v_cvt_pk_bf16_f32 v16, v108, v109
  v_cvt_pk_bf16_f32 v17, v110, v111
  v_mfma_f32_32x32x16_bf16 v[240:255], a[20:23], v[132:135], v[240:255]
  v_cvt_pk_bf16_f32 v18, v112, v113
  v_cvt_pk_bf16_f32 v19, v114, v115
  ds_write_b128 v146, v[16:19] offset:0
  v_mov_b32 v124, v108
  v_mul_f32 v125, v108, v108
  v_add_f32 v124, v124, v109
  v_fmac_f32 v125, v109, v109
  s_add_u32 s13, s56, 16384
  buffer_load_dwordx4 a[144:147], v2, s[40:43], s13 offen offset:2048 sc1
  v_mfma_f32_32x32x16_bf16 v[224:239], a[24:27], v[132:135], v[224:239]
  v_add_f32 v124, v124, v110
  v_fmac_f32 v125, v110, v110
  v_add_f32 v124, v124, v111
  v_fmac_f32 v125, v111, v111
  v_add_f32 v124, v124, v112
  v_fmac_f32 v125, v112, v112
  v_add_f32 v124, v124, v113
  v_mfma_f32_32x32x16_bf16 v[240:255], a[28:31], v[132:135], v[240:255]
  v_fmac_f32 v125, v113, v113
  v_add_f32 v124, v124, v114
  v_fmac_f32 v125, v114, v114
  v_add_f32 v124, v124, v115
  v_fmac_f32 v125, v115, v115
  v_lshlrev_b32 v108, 16, v20
  v_and_b32 v109, s64, v20
  s_add_u32 s13, s56, 45056
  buffer_load_dwordx4 a[148:151], v2, s[40:43], s13 offen offset:2048 sc1
  v_mfma_f32_32x32x16_bf16 v[224:239], a[32:35], v[132:135], v[224:239]
  v_lshlrev_b32 v110, 16, v21
  v_and_b32 v111, s64, v21
  v_lshlrev_b32 v112, 16, v22
  v_and_b32 v113, s64, v22
  v_lshlrev_b32 v114, 16, v23
  v_and_b32 v115, s64, v23
  v_fma_f32 v116, v108, v10, v11
  v_mfma_f32_32x32x16_bf16 v[240:255], a[36:39], v[132:135], v[240:255]
  v_fma_f32 v117, v109, v10, v11
  v_fma_f32 v118, v110, v10, v11
  v_fma_f32 v119, v111, v10, v11
  v_lshlrev_b32 v120, 16, v84
  v_and_b32 v121, s64, v84
  v_lshlrev_b32 v122, 16, v85
  v_and_b32 v123, s64, v85
  s_add_u32 s13, s56, 16384
  buffer_load_dwordx4 a[152:155], v2, s[40:43], s13 offen offset:3072 sc1
  v_mfma_f32_32x32x16_bf16 v[224:239], a[40:43], v[132:135], v[224:239]
  v_fmac_f32 v108, v116, v120
  v_fmac_f32 v109, v117, v121
  v_fmac_f32 v110, v118, v122
  v_fmac_f32 v111, v119, v123
  v_fma_f32 v116, v112, v10, v11
  v_fma_f32 v117, v113, v10, v11
  v_fma_f32 v118, v114, v10, v11
  v_mfma_f32_32x32x16_bf16 v[240:255], a[44:47], v[132:135], v[240:255]
  v_fma_f32 v119, v115, v10, v11
  v_lshlrev_b32 v120, 16, v86
  v_and_b32 v121, s64, v86
  v_lshlrev_b32 v122, 16, v87
  v_and_b32 v123, s64, v87
  v_fmac_f32 v112, v116, v120
  v_fmac_f32 v113, v117, v121
  s_add_u32 s13, s56, 45056
  buffer_load_dwordx4 a[156:159], v2, s[40:43], s13 offen offset:3072 sc1
  v_mfma_f32_32x32x16_bf16 v[224:239], a[48:51], v[132:135], v[224:239]
  v_fmac_f32 v114, v118, v122
  v_fmac_f32 v115, v119, v123
  v_cvt_pk_bf16_f32 v20, v108, v109
  v_cvt_pk_bf16_f32 v21, v110, v111
  v_cvt_pk_bf16_f32 v22, v112, v113
  v_cvt_pk_bf16_f32 v23, v114, v115
  ds_write_b128 v146, v[20:23] offset:4096
  v_mfma_f32_32x32x16_bf16 v[240:255], a[52:55], v[132:135], v[240:255]
  v_add_f32 v124, v124, v108
  v_fmac_f32 v125, v108, v108
  v_add_f32 v124, v124, v109
  v_fmac_f32 v125, v109, v109
  v_add_f32 v124, v124, v110
  v_fmac_f32 v125, v110, v110
  v_add_f32 v124, v124, v111
  s_add_u32 s13, s56, 20480
  buffer_load_dwordx4 a[160:163], v2, s[40:43], s13 offen offset:0 sc1
  v_mfma_f32_32x32x16_bf16 v[224:239], a[56:59], v[132:135], v[224:239]
  v_fmac_f32 v125, v111, v111
  v_add_f32 v124, v124, v112
  v_fmac_f32 v125, v112, v112
  v_add_f32 v124, v124, v113
  v_fmac_f32 v125, v113, v113
  v_add_f32 v124, v124, v114
  v_fmac_f32 v125, v114, v114
  v_mfma_f32_32x32x16_bf16 v[240:255], a[60:63], v[132:135], v[240:255]
  v_add_f32 v124, v124, v115
  v_fmac_f32 v125, v115, v115
  v_lshlrev_b32 v108, 16, v24
  v_and_b32 v109, s64, v24
  v_lshlrev_b32 v110, 16, v25
  v_and_b32 v111, s64, v25
  v_lshlrev_b32 v112, 16, v26
  s_add_u32 s13, s56, 49152
  buffer_load_dwordx4 a[164:167], v2, s[40:43], s13 offen offset:0 sc1
  v_mfma_f32_32x32x16_bf16 v[224:239], a[64:67], v[132:135], v[224:239]
  v_and_b32 v113, s64, v26
  v_lshlrev_b32 v114, 16, v27
  v_and_b32 v115, s64, v27
  v_fma_f32 v116, v108, v10, v11
  v_fma_f32 v117, v109, v10, v11
  v_fma_f32 v118, v110, v10, v11
  v_fma_f32 v119, v111, v10, v11
  v_mfma_f32_32x32x16_bf16 v[240:255], a[68:71], v[132:135], v[240:255]
  v_lshlrev_b32 v120, 16, v88
  v_and_b32 v121, s64, v88
  v_lshlrev_b32 v122, 16, v89
  v_and_b32 v123, s64, v89
  v_fmac_f32 v108, v116, v120
  v_fmac_f32 v109, v117, v121
  v_fmac_f32 v110, v118, v122
  s_add_u32 s13, s56, 20480
  buffer_load_dwordx4 a[168:171], v2, s[40:43], s13 offen offset:1024 sc1
  v_mfma_f32_32x32x16_bf16 v[224:239], a[72:75], v[132:135], v[224:239]
  v_fmac_f32 v111, v119, v123
  v_fma_f32 v116, v112, v10, v11
  v_fma_f32 v117, v113, v10, v11
  v_fma_f32 v118, v114, v10, v11
  v_fma_f32 v119, v115, v10, v11
  v_lshlrev_b32 v120, 16, v90
  v_and_b32 v121, s64, v90
  v_mfma_f32_32x32x16_bf16 v[240:255], a[76:79], v[132:135], v[240:255]
  v_lshlrev_b32 v122, 16, v91
  v_and_b32 v123, s64, v91
  v_fmac_f32 v112, v116, v120
  v_fmac_f32 v113, v117, v121
  v_fmac_f32 v114, v118, v122
  v_fmac_f32 v115, v119, v123
  v_cvt_pk_bf16_f32 v24, v108, v109
  s_add_u32 s13, s56, 49152
  buffer_load_dwordx4 a[172:175], v2, s[40:43], s13 offen offset:1024 sc1
  v_mfma_f32_32x32x16_bf16 v[224:239], a[80:83], v[132:135], v[224:239]
  v_cvt_pk_bf16_f32 v25, v110, v111
  v_cvt_pk_bf16_f32 v26, v112, v113
  v_cvt_pk_bf16_f32 v27, v114, v115
  ds_write_b128 v146, v[24:27] offset:8192
  v_add_f32 v124, v124, v108
  v_fmac_f32 v125, v108, v108
  v_add_f32 v124, v124, v109
  v_mfma_f32_32x32x16_bf16 v[240:255], a[84:87], v[132:135], v[240:255]
  v_fmac_f32 v125, v109, v109
  v_add_f32 v124, v124, v110
  v_fmac_f32 v125, v110, v110
  v_add_f32 v124, v124, v111
  v_fmac_f32 v125, v111, v111
  v_add_f32 v124, v124, v112
  v_fmac_f32 v125, v112, v112
  s_add_u32 s13, s56, 20480
  buffer_load_dwordx4 a[176:179], v2, s[40:43], s13 offen offset:2048 sc1
  s_waitcnt vmcnt(22)
  v_mfma_f32_32x32x16_bf16 v[224:239], a[88:91], v[132:135], v[224:239]
  v_add_f32 v124, v124, v113
  v_fmac_f32 v125, v113, v113
  v_add_f32 v124, v124, v114
  v_fmac_f32 v125, v114, v114
  v_add_f32 v124, v124, v115
  v_fmac_f32 v125, v115, v115
  v_lshlrev_b32 v108, 16, v28
  v_mfma_f32_32x32x16_bf16 v[240:255], a[92:95], v[132:135], v[240:255]
  v_and_b32 v109, s64, v28
  v_lshlrev_b32 v110, 16, v29
  v_and_b32 v111, s64, v29
  v_lshlrev_b32 v112, 16, v30
  v_and_b32 v113, s64, v30
  v_lshlrev_b32 v114, 16, v31
  v_and_b32 v115, s64, v31
  s_add_u32 s13, s56, 49152
  buffer_load_dwordx4 a[180:183], v2, s[40:43], s13 offen offset:2048 sc1
  s_waitcnt vmcnt(21)
  v_mfma_f32_32x32x16_bf16 v[224:239], a[96:99], v[132:135], v[224:239]
  v_fma_f32 v116, v108, v10, v11
  v_fma_f32 v117, v109, v10, v11
  v_fma_f32 v118, v110, v10, v11
  v_fma_f32 v119, v111, v10, v11
  v_lshlrev_b32 v120, 16, v92
  v_and_b32 v121, s64, v92
  v_lshlrev_b32 v122, 16, v93
  v_mfma_f32_32x32x16_bf16 v[240:255], a[100:103], v[132:135], v[240:255]
  v_and_b32 v123, s64, v93
  v_fmac_f32 v108, v116, v120
  v_fmac_f32 v109, v117, v121
  v_fmac_f32 v110, v118, v122
  v_fmac_f32 v111, v119, v123
  v_fma_f32 v116, v112, v10, v11
  v_fma_f32 v117, v113, v10, v11
  s_add_u32 s13, s56, 20480
  buffer_load_dwordx4 a[184:187], v2, s[40:43], s13 offen offset:3072 sc1
  s_waitcnt vmcnt(20)
  v_mfma_f32_32x32x16_bf16 v[224:239], a[104:107], v[132:135], v[224:239]
  v_fma_f32 v118, v114, v10, v11
  v_fma_f32 v119, v115, v10, v11
  v_lshlrev_b32 v120, 16, v94
  v_and_b32 v121, s64, v94
  v_lshlrev_b32 v122, 16, v95
  v_and_b32 v123, s64, v95
  v_fmac_f32 v112, v116, v120
  v_mfma_f32_32x32x16_bf16 v[240:255], a[108:111], v[132:135], v[240:255]
  v_fmac_f32 v113, v117, v121
  v_fmac_f32 v114, v118, v122
  v_fmac_f32 v115, v119, v123
  v_cvt_pk_bf16_f32 v28, v108, v109
  v_cvt_pk_bf16_f32 v29, v110, v111
  v_cvt_pk_bf16_f32 v30, v112, v113
  v_cvt_pk_bf16_f32 v31, v114, v115
  s_add_u32 s13, s56, 49152
  buffer_load_dwordx4 a[188:191], v2, s[40:43], s13 offen offset:3072 sc1
  s_waitcnt vmcnt(19)
  v_mfma_f32_32x32x16_bf16 v[224:239], a[112:115], v[132:135], v[224:239]
  ds_write_b128 v146, v[28:31] offset:12288
  v_add_f32 v124, v124, v108
  v_fmac_f32 v125, v108, v108
  v_add_f32 v124, v124, v109
  v_fmac_f32 v125, v109, v109
  v_add_f32 v124, v124, v110
  v_fmac_f32 v125, v110, v110
  v_mfma_f32_32x32x16_bf16 v[240:255], a[116:119], v[132:135], v[240:255]
  v_add_f32 v124, v124, v111
  v_fmac_f32 v125, v111, v111
  v_add_f32 v124, v124, v112
  v_fmac_f32 v125, v112, v112
  v_add_f32 v124, v124, v113
  v_fmac_f32 v125, v113, v113
  v_add_f32 v124, v124, v114
  s_add_u32 s13, s56, 24576
  buffer_load_dwordx4 a[192:195], v2, s[40:43], s13 offen offset:0 sc1
  s_waitcnt vmcnt(18)
  v_mfma_f32_32x32x16_bf16 v[224:239], a[120:123], v[132:135], v[224:239]
  v_fmac_f32 v125, v114, v114
  v_add_f32 v124, v124, v115
  v_fmac_f32 v125, v115, v115
  v_lshlrev_b32 v108, 16, v32
  v_and_b32 v109, s64, v32
  v_lshlrev_b32 v110, 16, v33
  v_and_b32 v111, s64, v33
  v_mfma_f32_32x32x16_bf16 v[240:255], a[124:127], v[132:135], v[240:255]
  v_lshlrev_b32 v112, 16, v34
  v_and_b32 v113, s64, v34
  v_lshlrev_b32 v114, 16, v35
  v_and_b32 v115, s64, v35
  v_fma_f32 v116, v108, v10, v11
  v_fma_f32 v117, v109, v10, v11
  v_fma_f32 v118, v110, v10, v11
  s_add_u32 s13, s56, 53248
  buffer_load_dwordx4 a[196:199], v2, s[40:43], s13 offen offset:0 sc1
  s_waitcnt vmcnt(17)
  v_mfma_f32_32x32x16_bf16 v[224:239], a[128:131], v[132:135], v[224:239]
  v_fma_f32 v119, v111, v10, v11
  v_lshlrev_b32 v120, 16, v96
  v_and_b32 v121, s64, v96
  v_lshlrev_b32 v122, 16, v97
  v_and_b32 v123, s64, v97
  v_fmac_f32 v108, v116, v120
  v_fmac_f32 v109, v117, v121
  v_mfma_f32_32x32x16_bf16 v[240:255], a[132:135], v[132:135], v[240:255]
  v_fmac_f32 v110, v118, v122
  v_fmac_f32 v111, v119, v123
  v_fma_f32 v116, v112, v10, v11
  v_fma_f32 v117, v113, v10, v11
  v_fma_f32 v118, v114, v10, v11
  v_fma_f32 v119, v115, v10, v11
  v_lshlrev_b32 v120, 16, v98
  s_add_u32 s13, s56, 24576
  buffer_load_dwordx4 a[200:203], v2, s[40:43], s13 offen offset:1024 sc1
  s_waitcnt vmcnt(15)
  v_mfma_f32_32x32x16_bf16 v[224:239], a[136:139], v[132:135], v[224:239]
  v_and_b32 v121, s64, v98
  v_lshlrev_b32 v122, 16, v99
  v_and_b32 v123, s64, v99
  v_fmac_f32 v112, v116, v120
  v_fmac_f32 v113, v117, v121
  v_fmac_f32 v114, v118, v122
  v_fmac_f32 v115, v119, v123
  v_mfma_f32_32x32x16_bf16 v[240:255], a[140:143], v[132:135], v[240:255]
  v_cvt_pk_bf16_f32 v32, v108, v109
  v_cvt_pk_bf16_f32 v33, v110, v111
  v_cvt_pk_bf16_f32 v34, v112, v113
  v_cvt_pk_bf16_f32 v35, v114, v115
  ds_write_b128 v146, v[32:35] offset:16384
  v_add_f32 v124, v124, v108
  v_fmac_f32 v125, v108, v108
  s_add_u32 s13, s56, 53248
  buffer_load_dwordx4 a[204:207], v2, s[40:43], s13 offen offset:1024 sc1
  s_waitcnt vmcnt(14)
  v_mfma_f32_32x32x16_bf16 v[224:239], a[144:147], v[132:135], v[224:239]
  v_add_f32 v124, v124, v109
  v_fmac_f32 v125, v109, v109
  v_add_f32 v124, v124, v110
  v_fmac_f32 v125, v110, v110
  v_add_f32 v124, v124, v111
  v_fmac_f32 v125, v111, v111
  v_add_f32 v124, v124, v112
  v_mfma_f32_32x32x16_bf16 v[240:255], a[148:151], v[132:135], v[240:255]
  v_fmac_f32 v125, v112, v112
  v_add_f32 v124, v124, v113
  v_fmac_f32 v125, v113, v113
  v_add_f32 v124, v124, v114
  v_fmac_f32 v125, v114, v114
  v_add_f32 v124, v124, v115
  v_fmac_f32 v125, v115, v115
  s_add_u32 s13, s56, 24576
  buffer_load_dwordx4 a[208:211], v2, s[40:43], s13 offen offset:2048 sc1
  s_waitcnt vmcnt(13)
  v_mfma_f32_32x32x16_bf16 v[224:239], a[152:155], v[132:135], v[224:239]
  v_lshlrev_b32 v108, 16, v36
  v_and_b32 v109, s64, v36
  v_lshlrev_b32 v110, 16, v37
  v_and_b32 v111, s64, v37
  v_lshlrev_b32 v112, 16, v38
  v_and_b32 v113, s64, v38
  v_lshlrev_b32 v114, 16, v39
  v_mfma_f32_32x32x16_bf16 v[240:255], a[156:159], v[132:135], v[240:255]
  v_and_b32 v115, s64, v39
  v_fma_f32 v116, v108, v10, v11
  v_fma_f32 v117, v109, v10, v11
  v_fma_f32 v118, v110, v10, v11
  v_fma_f32 v119, v111, v10, v11
  v_lshlrev_b32 v120, 16, v100
  v_and_b32 v121, s64, v100
  s_add_u32 s13, s56, 53248
  buffer_load_dwordx4 a[212:215], v2, s[40:43], s13 offen offset:2048 sc1
  s_waitcnt vmcnt(12)
  v_mfma_f32_32x32x16_bf16 v[224:239], a[160:163], v[132:135], v[224:239]
  v_lshlrev_b32 v122, 16, v101
  v_and_b32 v123, s64, v101
  v_fmac_f32 v108, v116, v120
  v_fmac_f32 v109, v117, v121
  v_fmac_f32 v110, v118, v122
  v_fmac_f32 v111, v119, v123
  v_fma_f32 v116, v112, v10, v11
  v_mfma_f32_32x32x16_bf16 v[240:255], a[164:167], v[132:135], v[240:255]
  v_fma_f32 v117, v113, v10, v11
  v_fma_f32 v118, v114, v10, v11
  v_fma_f32 v119, v115, v10, v11
  v_lshlrev_b32 v120, 16, v102
  v_and_b32 v121, s64, v102
  v_lshlrev_b32 v122, 16, v103
  v_and_b32 v123, s64, v103
  s_add_u32 s13, s56, 24576
  buffer_load_dwordx4 a[216:219], v2, s[40:43], s13 offen offset:3072 sc1
  s_waitcnt vmcnt(11)
  v_mfma_f32_32x32x16_bf16 v[224:239], a[168:171], v[132:135], v[224:239]
  v_fmac_f32 v112, v116, v120
  v_fmac_f32 v113, v117, v121
  v_fmac_f32 v114, v118, v122
  v_fmac_f32 v115, v119, v123
  v_cvt_pk_bf16_f32 v36, v108, v109
  v_cvt_pk_bf16_f32 v37, v110, v111
  v_cvt_pk_bf16_f32 v38, v112, v113
  v_mfma_f32_32x32x16_bf16 v[240:255], a[172:175], v[132:135], v[240:255]
  v_cvt_pk_bf16_f32 v39, v114, v115
  ds_write_b128 v146, v[36:39] offset:20480
  v_add_f32 v124, v124, v108
  v_fmac_f32 v125, v108, v108
  v_add_f32 v124, v124, v109
  v_fmac_f32 v125, v109, v109
  v_add_f32 v124, v124, v110
  s_add_u32 s13, s56, 53248
  buffer_load_dwordx4 a[220:223], v2, s[40:43], s13 offen offset:3072 sc1
  s_waitcnt vmcnt(10)
  v_mfma_f32_32x32x16_bf16 v[224:239], a[176:179], v[132:135], v[224:239]
  v_fmac_f32 v125, v110, v110
  v_add_f32 v124, v124, v111
  v_fmac_f32 v125, v111, v111
  v_add_f32 v124, v124, v112
  v_fmac_f32 v125, v112, v112
  v_add_f32 v124, v124, v113
  v_fmac_f32 v125, v113, v113
  v_mfma_f32_32x32x16_bf16 v[240:255], a[180:183], v[132:135], v[240:255]
  v_add_f32 v124, v124, v114
  v_fmac_f32 v125, v114, v114
  v_add_f32 v124, v124, v115
  v_fmac_f32 v125, v115, v115
  v_lshlrev_b32 v108, 16, v40
  v_and_b32 v109, s64, v40
  v_lshlrev_b32 v110, 16, v41
  s_add_u32 s13, s57, 0
  buffer_load_dwordx4 a[224:227], v2, s[40:43], s13 offen offset:0 sc1
  s_waitcnt vmcnt(9)
  v_mfma_f32_32x32x16_bf16 v[224:239], a[184:187], v[132:135], v[224:239]
  v_and_b32 v111, s64, v41
  v_lshlrev_b32 v112, 16, v42
  v_and_b32 v113, s64, v42
  v_lshlrev_b32 v114, 16, v43
  v_and_b32 v115, s64, v43
  v_fma_f32 v116, v108, v10, v11
  v_fma_f32 v117, v109, v10, v11
  v_mfma_f32_32x32x16_bf16 v[240:255], a[188:191], v[132:135], v[240:255]
  v_fma_f32 v118, v110, v10, v11
  v_fma_f32 v119, v111, v10, v11
  v_lshlrev_b32 v120, 16, v104
  v_and_b32 v121, s64, v104
  v_lshlrev_b32 v122, 16, v105
  v_and_b32 v123, s64, v105
  v_fmac_f32 v108, v116, v120
  s_add_u32 s13, s57, 114688
  buffer_load_dwordx4 a[228:231], v2, s[40:43], s13 offen offset:0 sc1
  s_waitcnt vmcnt(8)
  v_mfma_f32_32x32x16_bf16 v[224:239], a[192:195], v[132:135], v[224:239]
  v_fmac_f32 v109, v117, v121
  v_fmac_f32 v110, v118, v122
  v_fmac_f32 v111, v119, v123
  v_fma_f32 v116, v112, v10, v11
  v_fma_f32 v117, v113, v10, v11
  v_fma_f32 v118, v114, v10, v11
  v_fma_f32 v119, v115, v10, v11
  v_mfma_f32_32x32x16_bf16 v[240:255], a[196:199], v[132:135], v[240:255]
  v_lshlrev_b32 v120, 16, v106
  v_and_b32 v121, s64, v106
  v_lshlrev_b32 v122, 16, v107
  v_and_b32 v123, s64, v107
  v_fmac_f32 v112, v116, v120
  v_fmac_f32 v113, v117, v121
  v_fmac_f32 v114, v118, v122
  s_add_u32 s13, s57, 0
  buffer_load_dwordx4 a[232:235], v2, s[40:43], s13 offen offset:1024 sc1
  s_waitcnt vmcnt(7)
  v_mfma_f32_32x32x16_bf16 v[224:239], a[200:203], v[132:135], v[224:239]
  v_fmac_f32 v115, v119, v123
  v_cvt_pk_bf16_f32 v40, v108, v109
  v_cvt_pk_bf16_f32 v41, v110, v111
  v_cvt_pk_bf16_f32 v42, v112, v113
  v_cvt_pk_bf16_f32 v43, v114, v115
  ds_write_b128 v146, v[40:43] offset:24576
  v_add_f32 v124, v124, v108
  v_mfma_f32_32x32x16_bf16 v[240:255], a[204:207], v[132:135], v[240:255]
  v_fmac_f32 v125, v108, v108
  v_add_f32 v124, v124, v109
  v_fmac_f32 v125, v109, v109
  v_add_f32 v124, v124, v110
  v_fmac_f32 v125, v110, v110
  v_add_f32 v124, v124, v111
  v_fmac_f32 v125, v111, v111
  s_add_u32 s13, s57, 114688
  buffer_load_dwordx4 a[236:239], v2, s[40:43], s13 offen offset:1024 sc1
  s_waitcnt vmcnt(6)
  v_mfma_f32_32x32x16_bf16 v[224:239], a[208:211], v[132:135], v[224:239]
  v_add_f32 v124, v124, v112
  v_fmac_f32 v125, v112, v112
  v_add_f32 v124, v124, v113
  v_fmac_f32 v125, v113, v113
  v_add_f32 v124, v124, v114
  v_fmac_f32 v125, v114, v114
  v_add_f32 v124, v124, v115
  v_mfma_f32_32x32x16_bf16 v[240:255], a[212:215], v[132:135], v[240:255]
  v_fmac_f32 v125, v115, v115
  v_add_f32 v124, v124, v124 row_ror:8
  s_nop 0
  v_add_f32 v125, v125, v125 row_ror:8
  v_mov_b32 v126, v124
  v_mov_b32 v127, v125
  s_nop 0
  v_permlane16_swap_b32 v124, v126
  v_permlane16_swap_b32 v125, v127
  s_add_u32 s13, s57, 0
  buffer_load_dwordx4 a[240:243], v2, s[40:43], s13 offen offset:2048 sc1
  s_waitcnt vmcnt(5)
  v_mfma_f32_32x32x16_bf16 v[224:239], a[216:219], v[132:135], v[224:239]
  v_add_f32 v124, v124, v126
  v_add_f32 v125, v125, v127
  v_mov_b32 v126, v124
  v_mov_b32 v127, v125
  s_nop 0
  v_permlane32_swap_b32 v124, v126
  v_permlane32_swap_b32 v125, v127
  v_add_f32 v124, v124, v126
  v_mfma_f32_32x32x16_bf16 v[240:255], a[220:223], v[132:135], v[240:255]
  v_add_f32 v125, v125, v127
  v_mul_f32 v124, s63, v124
  v_mul_f32 v126, v124, v124
  v_fma_f32 v125, s63, v125, -v126
  v_max_f32 v125, 0, v125
  v_cvt_pk_bf16_f32 v125, v125, v125
  v_lshlrev_b32 v125, 16, v125
  s_add_u32 s13, s57, 114688
  buffer_load_dwordx4 a[244:247], v2, s[40:43], s13 offen offset:2048 sc1
  v_add_f32 v125, 0x3727c5ac, v125
  v_cvt_pk_bf16_f32 v125, v125, v125
  v_lshlrev_b32 v125, 16, v125
  v_sqrt_f32 v125, v125
  s_nop 0
  v_cvt_pk_bf16_f32 v125, v125, v125
  v_lshlrev_b32 v125, 16, v125
  v_rcp_f32 v127, v125
  v_cvt_pk_bf16_f32 v124, v124, v124
  v_lshlrev_b32 v124, 16, v124
  v_sub_f32 v126, 0, v124
  s_mov_b64 exec, 0xff
  ds_write_b64 v147, v[126:127] offset:0
  s_mov_b64 exec, -1
  s_mov_b32 exec_lo, 1
  s_mov_b32 exec_hi, 1
  ds_write_b128 v151, v[224:227] offset:0
  ds_write_b128 v151, v[228:231] offset:16
  ds_write_b128 v151, v[232:235] offset:32
  ds_write_b128 v151, v[236:239] offset:48
  ds_write_b128 v151, v[240:243] offset:128
  ds_write_b128 v151, v[244:247] offset:144
  ds_write_b128 v151, v[248:251] offset:160
  ds_write_b128 v151, v[252:255] offset:176
  s_mov_b64 exec, -1
  s_waitcnt lgkmcnt(0)
  s_barrier
  ds_read_b128 v[132:135], v148 offset:0
  ds_read_b128 v[136:139], v148 offset:1024
  ds_read_b128 v[8:11], v149 offset:0
  ds_read_b64 v[156:157], v150 offset:0
  ds_read_b128 v[140:143], v148 offset:2048
  s_waitcnt lgkmcnt(4)
  v_mfma_f32_32x32x16_bf16 v[16:31], a[0:3], v[132:135], 0
  ds_read_b64_tr_b16 v[80:81], v128 offset:28736
  ds_read_b64_tr_b16 v[82:83], v129 offset:28736
  ds_read_b64_tr_b16 v[84:85], v128 offset:29760
  ds_read_b64_tr_b16 v[86:87], v129 offset:29760
  ds_read_b128 v[132:135], v148 offset:3072
  s_waitcnt lgkmcnt(8)
  v_mfma_f32_32x32x16_bf16 v[16:31], a[8:11], v[136:139], v[16:31]
  ds_read_b64_tr_b16 v[88:89], v128 offset:30784
  ds_read_b64_tr_b16 v[90:91], v129 offset:30784
  ds_read_b64_tr_b16 v[92:93], v128 offset:31808
  ds_read_b64_tr_b16 v[94:95], v129 offset:31808
  ds_read_b128 v[136:139], v148 offset:4096
  s_waitcnt lgkmcnt(10)
  v_mfma_f32_32x32x16_bf16 v[16:31], a[16:19], v[140:143], v[16:31]
  ds_read_b64_tr_b16 v[96:97], v128 offset:32832
  ds_read_b64_tr_b16 v[98:99], v129 offset:32832
  ds_read_b64_tr_b16 v[100:101], v128 offset:33856
  ds_read_b64_tr_b16 v[102:103], v129 offset:33856
  ds_read_b128 v[140:143], v148 offset:5120
  s_waitcnt lgkmcnt(10)
  v_mfma_f32_32x32x16_bf16 v[16:31], a[24:27], v[132:135], v[16:31]
  ds_read_b64_tr_b16 v[104:105], v128 offset:34880
  ds_read_b64_tr_b16 v[106:107], v129 offset:34880
  s_waitcnt lgkmcnt(0)
  s_waitcnt lgkmcnt(0)
  s_barrier
  ds_read_b128 v[132:135], v148 offset:6144
  v_mfma_f32_32x32x16_bf16 v[16:31], a[32:35], v[136:139], v[16:31]
  ds_read_b128 v[136:139], v148 offset:7168
  v_mfma_f32_32x32x16_bf16 v[16:31], a[40:43], v[140:143], v[16:31]
  ds_read_b128 v[140:143], v148 offset:8192
  s_waitcnt lgkmcnt(2)
  v_mfma_f32_32x32x16_bf16 v[16:31], a[48:51], v[132:135], v[16:31]
  ds_read_b128 v[132:135], v148 offset:9216
  s_waitcnt lgkmcnt(2)
  v_mfma_f32_32x32x16_bf16 v[16:31], a[56:59], v[136:139], v[16:31]
  ds_read_b128 v[136:139], v148 offset:10240
  s_waitcnt lgkmcnt(2)
  v_mfma_f32_32x32x16_bf16 v[16:31], a[64:67], v[140:143], v[16:31]
  s_add_u32 s13, s57, 0
  buffer_load_dwordx4 a[248:251], v2, s[40:43], s13 offen offset:3072 sc1
  ds_read_b128 v[140:143], v148 offset:11264
  s_waitcnt lgkmcnt(2)
  v_mfma_f32_32x32x16_bf16 v[16:31], a[72:75], v[132:135], v[16:31]
  ds_read_b128 v[132:135], v148 offset:12288
  s_waitcnt lgkmcnt(2)
  v_mfma_f32_32x32x16_bf16 v[16:31], a[80:83], v[136:139], v[16:31]
  s_add_u32 s13, s57, 114688
  buffer_load_dwordx4 a[252:255], v2, s[40:43], s13 offen offset:3072 sc1
  ds_read_b128 v[136:139], v148 offset:13312
  s_waitcnt lgkmcnt(2)
  v_mfma_f32_32x32x16_bf16 v[16:31], a[88:91], v[140:143], v[16:31]
  ds_read_b128 v[140:143], v148 offset:14336
  s_waitcnt lgkmcnt(2)
  v_mfma_f32_32x32x16_bf16 v[16:31], a[96:99], v[132:135], v[16:31]
  s_add_u32 s13, s57, 4096
  buffer_load_dwordx4 v[160:163], v2, s[40:43], s13 offen offset:0 sc1
  ds_read_b128 v[132:135], v148 offset:15360
  s_waitcnt lgkmcnt(2)
  v_mfma_f32_32x32x16_bf16 v[16:31], a[104:107], v[136:139], v[16:31]
  ds_read_b128 v[136:139], v148 offset:16384
  s_waitcnt lgkmcnt(2)
  v_mfma_f32_32x32x16_bf16 v[16:31], a[112:115], v[140:143], v[16:31]
  s_add_u32 s13, s57, 118784
  buffer_load_dwordx4 v[164:167], v2, s[40:43], s13 offen offset:0 sc1
  ds_read_b128 v[140:143], v148 offset:17408
  s_waitcnt lgkmcnt(2)
  v_mfma_f32_32x32x16_bf16 v[16:31], a[120:123], v[132:135], v[16:31]
  ds_read_b128 v[132:135], v148 offset:18432
  s_waitcnt lgkmcnt(2)
  v_mfma_f32_32x32x16_bf16 v[16:31], a[128:131], v[136:139], v[16:31]
  s_add_u32 s13, s57, 4096
  buffer_load_dwordx4 v[168:171], v2, s[40:43], s13 offen offset:1024 sc1
  ds_read_b128 v[136:139], v148 offset:19456
  s_waitcnt lgkmcnt(2)
  v_mfma_f32_32x32x16_bf16 v[16:31], a[136:139], v[140:143], v[16:31]
  ds_read_b128 v[140:143], v148 offset:20480
  s_waitcnt lgkmcnt(2)
  v_mfma_f32_32x32x16_bf16 v[16:31], a[144:147], v[132:135], v[16:31]
  s_add_u32 s13, s57, 118784
  buffer_load_dwordx4 v[172:175], v2, s[40:43], s13 offen offset:1024 sc1
  ds_read_b128 v[132:135], v148 offset:21504
  s_waitcnt lgkmcnt(2)
  v_mfma_f32_32x32x16_bf16 v[16:31], a[152:155], v[136:139], v[16:31]
  ds_read_b128 v[136:139], v148 offset:22528
  s_waitcnt lgkmcnt(2)
  v_mfma_f32_32x32x16_bf16 v[16:31], a[160:163], v[140:143], v[16:31]
  s_add_u32 s13, s57, 4096
  buffer_load_dwordx4 v[176:179], v2, s[40:43], s13 offen offset:2048 sc1
  ds_read_b128 v[140:143], v148 offset:23552
  s_waitcnt lgkmcnt(2)
  v_mfma_f32_32x32x16_bf16 v[16:31], a[168:171], v[132:135], v[16:31]
  ds_read_b128 v[132:135], v148 offset:24576
  s_waitcnt lgkmcnt(2)
  v_mfma_f32_32x32x16_bf16 v[16:31], a[176:179], v[136:139], v[16:31]
  s_add_u32 s13, s57, 118784
  buffer_load_dwordx4 v[180:183], v2, s[40:43], s13 offen offset:2048 sc1
  ds_read_b128 v[136:139], v148 offset:25600
  s_waitcnt lgkmcnt(2)
  v_mfma_f32_32x32x16_bf16 v[16:31], a[184:187], v[140:143], v[16:31]
  ds_read_b128 v[140:143], v148 offset:26624
  s_waitcnt lgkmcnt(2)
  v_mfma_f32_32x32x16_bf16 v[16:31], a[192:195], v[132:135], v[16:31]
  s_add_u32 s13, s57, 4096
  buffer_load_dwordx4 v[184:187], v2, s[40:43], s13 offen offset:3072 sc1
  ds_read_b128 v[132:135], v148 offset:27648
  s_waitcnt lgkmcnt(2)
  v_mfma_f32_32x32x16_bf16 v[16:31], a[200:203], v[136:139], v[16:31]
  ds_read_b128 v[136:139], v148 offset:0
  s_waitcnt lgkmcnt(2)
  v_mfma_f32_32x32x16_bf16 v[16:31], a[208:211], v[140:143], v[16:31]
  s_add_u32 s13, s57, 118784
  buffer_load_dwordx4 v[188:191], v2, s[40:43], s13 offen offset:3072 sc1
  ds_read_b128 v[140:143], v148 offset:1024
  s_waitcnt lgkmcnt(2)
  v_mfma_f32_32x32x16_bf16 v[16:31], a[216:219], v[132:135], v[16:31]
  ds_read_b128 v[132:135], v148 offset:2048
  s_waitcnt lgkmcnt(2)
  v_mfma_f32_32x32x16_bf16 v[32:47], a[4:7], v[136:139], 0
  s_add_u32 s13, s57, 8192
  buffer_load_dwordx4 v[192:195], v2, s[40:43], s13 offen offset:0 sc1
  ds_read_b128 v[136:139], v148 offset:3072
  s_waitcnt lgkmcnt(2)
  v_mfma_f32_32x32x16_bf16 v[32:47], a[12:15], v[140:143], v[32:47]
  s_add_u32 s73, s75, 16777216
  ds_read_b128 v[108:111], v151 offset:0
  ds_read_b128 v[112:115], v151 offset:16
  s_waitcnt lgkmcnt(0)
  ds_read_b128 v[140:143], v148 offset:4096
  v_mfma_f32_32x32x16_bf16 v[32:47], a[20:23], v[132:135], v[32:47]
  v_fmac_f32 v16, v108, v156
  v_fmac_f32 v17, v109, v156
  v_fmac_f32 v18, v110, v156
  v_fmac_f32 v19, v111, v156
  s_add_u32 s13, s57, 122880
  buffer_load_dwordx4 v[196:199], v2, s[40:43], s13 offen offset:0 sc1
  ds_read_b128 v[132:135], v148 offset:5120
  v_mfma_f32_32x32x16_bf16 v[32:47], a[28:31], v[136:139], v[32:47]
  v_fmac_f32 v20, v112, v156
  v_fmac_f32 v21, v113, v156
  v_fmac_f32 v22, v114, v156
  v_fmac_f32 v23, v115, v156
  ds_read_b128 v[136:139], v148 offset:6144
  s_waitcnt lgkmcnt(2)
  v_mfma_f32_32x32x16_bf16 v[32:47], a[36:39], v[140:143], v[32:47]
  ds_read_b128 v[108:111], v151 offset:32
  ds_read_b128 v[112:115], v151 offset:48
  s_waitcnt lgkmcnt(0)
  v_fmac_f32 v24, v108, v156
  s_add_u32 s13, s57, 8192
  buffer_load_dwordx4 v[200:203], v2, s[40:43], s13 offen offset:1024 sc1
  ds_read_b128 v[140:143], v148 offset:7168
  v_mfma_f32_32x32x16_bf16 v[32:47], a[44:47], v[132:135], v[32:47]
  v_fmac_f32 v25, v109, v156
  v_fmac_f32 v26, v110, v156
  v_fmac_f32 v27, v111, v156
  v_fmac_f32 v28, v112, v156
  ds_read_b128 v[132:135], v148 offset:8192
  v_mfma_f32_32x32x16_bf16 v[32:47], a[52:55], v[136:139], v[32:47]
  v_fmac_f32 v29, v113, v156
  v_fmac_f32 v30, v114, v156
  v_fmac_f32 v31, v115, v156
  v_max_f32 v16, 0, v16
  s_add_u32 s13, s57, 122880
  buffer_load_dwordx4 v[204:207], v2, s[40:43], s13 offen offset:1024 sc1
  ds_read_b128 v[136:139], v148 offset:9216
  s_waitcnt lgkmcnt(2)
  v_mfma_f32_32x32x16_bf16 v[32:47], a[60:63], v[140:143], v[32:47]
  v_max_f32 v17, 0, v17
  v_max_f32 v18, 0, v18
  v_max_f32 v19, 0, v19
  v_max_f32 v20, 0, v20
  ds_read_b128 v[140:143], v148 offset:10240
  s_waitcnt lgkmcnt(2)
  v_mfma_f32_32x32x16_bf16 v[32:47], a[68:71], v[132:135], v[32:47]
  v_max_f32 v21, 0, v21
  v_max_f32 v22, 0, v22
  v_max_f32 v23, 0, v23
  v_max_f32 v24, 0, v24
  s_add_u32 s13, s57, 8192
  buffer_load_dwordx4 v[208:211], v2, s[40:43], s13 offen offset:2048 sc1
  ds_read_b128 v[132:135], v148 offset:11264
  s_waitcnt lgkmcnt(2)
  v_mfma_f32_32x32x16_bf16 v[32:47], a[76:79], v[136:139], v[32:47]
  v_max_f32 v25, 0, v25
  v_max_f32 v26, 0, v26
  v_max_f32 v27, 0, v27
  v_max_f32 v28, 0, v28
  ds_read_b128 v[136:139], v148 offset:12288
  s_waitcnt lgkmcnt(2)
  v_mfma_f32_32x32x16_bf16 v[32:47], a[84:87], v[140:143], v[32:47]
  v_max_f32 v29, 0, v29
  v_max_f32 v30, 0, v30
  v_max_f32 v31, 0, v31
  v_cvt_pk_bf16_f32 v16, v16, v17
  s_add_u32 s13, s57, 122880
  buffer_load_dwordx4 v[212:215], v2, s[40:43], s13 offen offset:2048 sc1
  ds_read_b128 v[140:143], v148 offset:13312
  s_waitcnt lgkmcnt(2)
  v_mfma_f32_32x32x16_bf16 v[32:47], a[92:95], v[132:135], v[32:47]
  v_cvt_pk_bf16_f32 v17, v18, v19
  v_cvt_pk_bf16_f32 v18, v20, v21
  v_cvt_pk_bf16_f32 v19, v22, v23
  v_cvt_pk_bf16_f32 v20, v24, v25
  ds_read_b128 v[132:135], v148 offset:14336
  s_waitcnt lgkmcnt(2)
  v_mfma_f32_32x32x16_bf16 v[32:47], a[100:103], v[136:139], v[32:47]
  v_cvt_pk_bf16_f32 v21, v26, v27
  v_cvt_pk_bf16_f32 v22, v28, v29
  v_cvt_pk_bf16_f32 v23, v30, v31
  buffer_store_dwordx4 v[16:19], v2, s[40:43], s73 offen offset:0 sc1
  s_add_u32 s13, s57, 8192
  buffer_load_dwordx4 v[216:219], v2, s[40:43], s13 offen offset:3072 sc1
  ds_read_b128 v[136:139], v148 offset:15360
  s_waitcnt lgkmcnt(2)
  v_mfma_f32_32x32x16_bf16 v[32:47], a[108:111], v[140:143], v[32:47]
  buffer_store_dwordx4 v[20:23], v2, s[40:43], s73 offen offset:1024 sc1
  ds_read_b128 v[140:143], v148 offset:16384
  s_waitcnt lgkmcnt(2)
  v_mfma_f32_32x32x16_bf16 v[32:47], a[116:119], v[132:135], v[32:47]
  s_add_u32 s13, s57, 122880
  buffer_load_dwordx4 v[220:223], v2, s[40:43], s13 offen offset:3072 sc1
  ds_read_b128 v[132:135], v148 offset:17408
  s_waitcnt lgkmcnt(2)
  v_mfma_f32_32x32x16_bf16 v[32:47], a[124:127], v[136:139], v[32:47]
  ds_read_b128 v[136:139], v148 offset:18432
  s_waitcnt lgkmcnt(2)
  v_mfma_f32_32x32x16_bf16 v[32:47], a[132:135], v[140:143], v[32:47]
  s_add_u32 m0, s59, 65536
  s_add_u32 s13, s57, 24576
  buffer_load_dwordx4 v2, s[40:43], s13 offen sc1 lds
  ds_read_b128 v[140:143], v148 offset:19456
  s_waitcnt lgkmcnt(2)
  v_mfma_f32_32x32x16_bf16 v[32:47], a[140:143], v[132:135], v[32:47]
  ds_read_b128 v[132:135], v148 offset:20480
  s_waitcnt lgkmcnt(2)
  v_mfma_f32_32x32x16_bf16 v[32:47], a[148:151], v[136:139], v[32:47]
  s_add_u32 m0, s59, 66560
  s_add_u32 s13, s57, 139264
  buffer_load_dwordx4 v2, s[40:43], s13 offen sc1 lds
  ds_read_b128 v[136:139], v148 offset:21504
  s_waitcnt lgkmcnt(2)
  v_mfma_f32_32x32x16_bf16 v[32:47], a[156:159], v[140:143], v[32:47]
  ds_read_b128 v[140:143], v148 offset:22528
  s_waitcnt lgkmcnt(2)
  v_mfma_f32_32x32x16_bf16 v[32:47], a[164:167], v[132:135], v[32:47]
  s_add_u32 m0, s59, 73728
  s_add_u32 s13, s57, 25600
  buffer_load_dwordx4 v2, s[40:43], s13 offen sc1 lds
  ds_read_b128 v[132:135], v148 offset:23552
  s_waitcnt lgkmcnt(2)
  v_mfma_f32_32x32x16_bf16 v[32:47], a[172:175], v[136:139], v[32:47]
  ds_read_b128 v[136:139], v148 offset:24576
  s_waitcnt lgkmcnt(2)
  v_mfma_f32_32x32x16_bf16 v[32:47], a[180:183], v[140:143], v[32:47]
  s_add_u32 m0, s59, 74752
  s_add_u32 s13, s57, 140288
  buffer_load_dwordx4 v2, s[40:43], s13 offen sc1 lds
  ds_read_b128 v[140:143], v148 offset:25600
  s_waitcnt lgkmcnt(2)
  v_mfma_f32_32x32x16_bf16 v[32:47], a[188:191], v[132:135], v[32:47]
  ds_read_b128 v[132:135], v148 offset:26624
  s_waitcnt lgkmcnt(2)
  v_mfma_f32_32x32x16_bf16 v[32:47], a[196:199], v[136:139], v[32:47]
  s_add_u32 m0, s59, 81920
  s_add_u32 s13, s57, 26624
  buffer_load_dwordx4 v2, s[40:43], s13 offen sc1 lds
  ds_read_b128 v[136:139], v148 offset:27648
  s_waitcnt lgkmcnt(2)
  v_mfma_f32_32x32x16_bf16 v[32:47], a[204:207], v[140:143], v[32:47]
  s_waitcnt lgkmcnt(1)
  v_mfma_f32_32x32x16_bf16 v[32:47], a[212:215], v[132:135], v[32:47]
  s_add_u32 m0, s59, 82944
  s_add_u32 s13, s57, 141312
  buffer_load_dwordx4 v2, s[40:43], s13 offen sc1 lds
  s_waitcnt lgkmcnt(0)
  v_mfma_f32_32x32x16_bf16 v[32:47], a[220:223], v[136:139], v[32:47]
  s_add_u32 s73, s75, 16777216
  ds_read_b128 v[108:111], v151 offset:128
  ds_read_b128 v[112:115], v151 offset:144
  s_waitcnt lgkmcnt(0)
  s_nop 7
  v_fmac_f32 v32, v108, v156
  v_fmac_f32 v33, v109, v156
  v_fmac_f32 v34, v110, v156
  v_fmac_f32 v35, v111, v156
  v_fmac_f32 v36, v112, v156
  v_fmac_f32 v37, v113, v156
  v_fmac_f32 v38, v114, v156
  v_fmac_f32 v39, v115, v156
  ds_read_b128 v[108:111], v151 offset:160
  ds_read_b128 v[112:115], v151 offset:176
  s_waitcnt lgkmcnt(0)
  v_fmac_f32 v40, v108, v156
  v_fmac_f32 v41, v109, v156
  v_fmac_f32 v42, v110, v156
  v_fmac_f32 v43, v111, v156
  v_fmac_f32 v44, v112, v156
  v_fmac_f32 v45, v113, v156
  v_fmac_f32 v46, v114, v156
  v_fmac_f32 v47, v115, v156
  v_cvt_pk_bf16_f32 v32, v32, v33
  v_cvt_pk_bf16_f32 v33, v34, v35
  v_cvt_pk_bf16_f32 v34, v36, v37
  v_cvt_pk_bf16_f32 v35, v38, v39
  v_cvt_pk_bf16_f32 v36, v40, v41
  v_cvt_pk_bf16_f32 v37, v42, v43
  v_cvt_pk_bf16_f32 v38, v44, v45
  v_cvt_pk_bf16_f32 v39, v46, v47
  v_pk_max_i16 v32, v32, 0
  v_pk_max_i16 v33, v33, 0
  v_pk_max_i16 v34, v34, 0
  v_pk_max_i16 v35, v35, 0
  v_pk_max_i16 v36, v36, 0
  v_pk_max_i16 v37, v37, 0
  v_pk_max_i16 v38, v38, 0
  v_pk_max_i16 v39, v39, 0
  buffer_store_dwordx4 v[32:35], v2, s[40:43], s73 offen offset:2048 sc1
  buffer_store_dwordx4 v[36:39], v2, s[40:43], s73 offen offset:3072 sc1
  s_lshl_b32 s72, s5, 10
  s_add_u32 s72, s72, s71
  s_add_u32 s72, s72, 4222976
  s_cmp_lg_u32 s5, 0
  s_cbranch_scc1 P3_01_YX0
  buffer_store_dwordx4 v[80:83], v2, s[40:43], s72 offen sc1
P3_01_YX0:
  s_cmp_lg_u32 s5, 1
  s_cbranch_scc1 P3_01_YX1
  buffer_store_dwordx4 v[84:87], v2, s[40:43], s72 offen sc1
P3_01_YX1:
  s_cmp_lg_u32 s5, 2
  s_cbranch_scc1 P3_01_YX2
  buffer_store_dwordx4 v[88:91], v2, s[40:43], s72 offen sc1
P3_01_YX2:
  s_cmp_lg_u32 s5, 3
  s_cbranch_scc1 P3_01_YX3
  buffer_store_dwordx4 v[92:95], v2, s[40:43], s72 offen sc1
P3_01_YX3:
  s_cmp_lg_u32 s5, 4
  s_cbranch_scc1 P3_01_YX4
  buffer_store_dwordx4 v[96:99], v2, s[40:43], s72 offen sc1
P3_01_YX4:
  s_cmp_lg_u32 s5, 5
  s_cbranch_scc1 P3_01_YX5
  buffer_store_dwordx4 v[100:103], v2, s[40:43], s72 offen sc1
P3_01_YX5:
  s_cmp_lg_u32 s5, 6
  s_cbranch_scc1 P3_01_YX6
  buffer_store_dwordx4 v[104:107], v2, s[40:43], s72 offen sc1
P3_01_YX6:
  v_lshlrev_b32 v108, 16, v48
  v_and_b32 v109, s64, v48
  v_lshlrev_b32 v110, 16, v49
  v_and_b32 v111, s64, v49
  v_lshlrev_b32 v112, 16, v50
  v_and_b32 v113, s64, v50
  v_lshlrev_b32 v114, 16, v51
  v_and_b32 v115, s64, v51
  v_pk_fma_f32 v[116:117], v[108:109], v[14:15], v[14:15] op_sel:[0,0,1] op_sel_hi:[1,0,1]
  v_pk_fma_f32 v[118:119], v[110:111], v[14:15], v[14:15] op_sel:[0,0,1] op_sel_hi:[1,0,1]
  v_lshlrev_b32 v120, 16, v80
  v_and_b32 v121, s64, v80
  v_lshlrev_b32 v122, 16, v81
  v_and_b32 v123, s64, v81
  v_pk_fma_f32 v[108:109], v[116:117], v[120:121], v[108:109]
  v_pk_fma_f32 v[110:111], v[118:119], v[122:123], v[110:111]
  v_pk_fma_f32 v[116:117], v[112:113], v[14:15], v[14:15] op_sel:[0,0,1] op_sel_hi:[1,0,1]
  v_pk_fma_f32 v[118:119], v[114:115], v[14:15], v[14:15] op_sel:[0,0,1] op_sel_hi:[1,0,1]
  v_lshlrev_b32 v120, 16, v82
  v_and_b32 v121, s64, v82
  v_lshlrev_b32 v122, 16, v83
  v_and_b32 v123, s64, v83
  v_pk_fma_f32 v[112:113], v[116:117], v[120:121], v[112:113]
  v_pk_fma_f32 v[114:115], v[118:119], v[122:123], v[114:115]
  v_cvt_pk_bf16_f32 v48, v108, v109
  v_cvt_pk_bf16_f32 v49, v110, v111
  v_cvt_pk_bf16_f32 v50, v112, v113
  v_cvt_pk_bf16_f32 v51, v114, v115
  ds_write_b128 v146, v[48:51] offset:28736
  v_dot2_f32_bf16 v124, v48, s62, 0
  v_dot2_f32_bf16 v125, v48, v48, 0
  v_dot2_f32_bf16 v124, v49, s62, v124
  v_dot2_f32_bf16 v125, v49, v49, v125
  v_dot2_f32_bf16 v124, v50, s62, v124
  v_dot2_f32_bf16 v125, v50, v50, v125
  v_dot2_f32_bf16 v124, v51, s62, v124
  v_dot2_f32_bf16 v125, v51, v51, v125
  v_lshlrev_b32 v108, 16, v52
  v_and_b32 v109, s64, v52
  v_lshlrev_b32 v110, 16, v53
  v_and_b32 v111, s64, v53
  v_lshlrev_b32 v112, 16, v54
  v_and_b32 v113, s64, v54
  v_lshlrev_b32 v114, 16, v55
  v_and_b32 v115, s64, v55
  v_pk_fma_f32 v[116:117], v[108:109], v[14:15], v[14:15] op_sel:[0,0,1] op_sel_hi:[1,0,1]
  v_pk_fma_f32 v[118:119], v[110:111], v[14:15], v[14:15] op_sel:[0,0,1] op_sel_hi:[1,0,1]
  v_lshlrev_b32 v120, 16, v84
  v_and_b32 v121, s64, v84
  v_lshlrev_b32 v122, 16, v85
  v_and_b32 v123, s64, v85
  v_pk_fma_f32 v[108:109], v[116:117], v[120:121], v[108:109]
  v_pk_fma_f32 v[110:111], v[118:119], v[122:123], v[110:111]
  v_pk_fma_f32 v[116:117], v[112:113], v[14:15], v[14:15] op_sel:[0,0,1] op_sel_hi:[1,0,1]
  v_pk_fma_f32 v[118:119], v[114:115], v[14:15], v[14:15] op_sel:[0,0,1] op_sel_hi:[1,0,1]
  v_lshlrev_b32 v120, 16, v86
  v_and_b32 v121, s64, v86
  v_lshlrev_b32 v122, 16, v87
  v_and_b32 v123, s64, v87
  v_pk_fma_f32 v[112:113], v[116:117], v[120:121], v[112:113]
  v_pk_fma_f32 v[114:115], v[118:119], v[122:123], v[114:115]
  v_cvt_pk_bf16_f32 v52, v108, v109
  v_cvt_pk_bf16_f32 v53, v110, v111
  v_cvt_pk_bf16_f32 v54, v112, v113
  v_cvt_pk_bf16_f32 v55, v114, v115
  ds_write_b128 v146, v[52:55] offset:32832
  v_dot2_f32_bf16 v124, v52, s62, v124
  v_dot2_f32_bf16 v125, v52, v52, v125
  v_dot2_f32_bf16 v124, v53, s62, v124
  v_dot2_f32_bf16 v125, v53, v53, v125
  v_dot2_f32_bf16 v124, v54, s62, v124
  v_dot2_f32_bf16 v125, v54, v54, v125
  v_dot2_f32_bf16 v124, v55, s62, v124
  v_dot2_f32_bf16 v125, v55, v55, v125
  v_lshlrev_b32 v108, 16, v56
  v_and_b32 v109, s64, v56
  v_lshlrev_b32 v110, 16, v57
  v_and_b32 v111, s64, v57
  v_lshlrev_b32 v112, 16, v58
  v_and_b32 v113, s64, v58
  v_lshlrev_b32 v114, 16, v59
  v_and_b32 v115, s64, v59
  v_pk_fma_f32 v[116:117], v[108:109], v[14:15], v[14:15] op_sel:[0,0,1] op_sel_hi:[1,0,1]
  v_pk_fma_f32 v[118:119], v[110:111], v[14:15], v[14:15] op_sel:[0,0,1] op_sel_hi:[1,0,1]
  v_lshlrev_b32 v120, 16, v88
  v_and_b32 v121, s64, v88
  v_lshlrev_b32 v122, 16, v89
  v_and_b32 v123, s64, v89
  v_pk_fma_f32 v[108:109], v[116:117], v[120:121], v[108:109]
  v_pk_fma_f32 v[110:111], v[118:119], v[122:123], v[110:111]
  v_pk_fma_f32 v[116:117], v[112:113], v[14:15], v[14:15] op_sel:[0,0,1] op_sel_hi:[1,0,1]
  v_pk_fma_f32 v[118:119], v[114:115], v[14:15], v[14:15] op_sel:[0,0,1] op_sel_hi:[1,0,1]
  v_lshlrev_b32 v120, 16, v90
  v_and_b32 v121, s64, v90
  v_lshlrev_b32 v122, 16, v91
  v_and_b32 v123, s64, v91
  v_pk_fma_f32 v[112:113], v[116:117], v[120:121], v[112:113]
  v_pk_fma_f32 v[114:115], v[118:119], v[122:123], v[114:115]
  v_cvt_pk_bf16_f32 v56, v108, v109
  v_cvt_pk_bf16_f32 v57, v110, v111
  v_cvt_pk_bf16_f32 v58, v112, v113
  v_cvt_pk_bf16_f32 v59, v114, v115
  ds_write_b128 v146, v[56:59] offset:36928
  v_dot2_f32_bf16 v124, v56, s62, v124
  v_dot2_f32_bf16 v125, v56, v56, v125
  v_dot2_f32_bf16 v124, v57, s62, v124
  v_dot2_f32_bf16 v125, v57, v57, v125
  v_dot2_f32_bf16 v124, v58, s62, v124
  v_dot2_f32_bf16 v125, v58, v58, v125
  v_dot2_f32_bf16 v124, v59, s62, v124
  v_dot2_f32_bf16 v125, v59, v59, v125
  v_lshlrev_b32 v108, 16, v60
  v_and_b32 v109, s64, v60
  v_lshlrev_b32 v110, 16, v61
  v_and_b32 v111, s64, v61
  v_lshlrev_b32 v112, 16, v62
  v_and_b32 v113, s64, v62
  v_lshlrev_b32 v114, 16, v63
  v_and_b32 v115, s64, v63
  v_pk_fma_f32 v[116:117], v[108:109], v[14:15], v[14:15] op_sel:[0,0,1] op_sel_hi:[1,0,1]
  v_pk_fma_f32 v[118:119], v[110:111], v[14:15], v[14:15] op_sel:[0,0,1] op_sel_hi:[1,0,1]
  v_lshlrev_b32 v120, 16, v92
  v_and_b32 v121, s64, v92
  v_lshlrev_b32 v122, 16, v93
  v_and_b32 v123, s64, v93
  v_pk_fma_f32 v[108:109], v[116:117], v[120:121], v[108:109]
  v_pk_fma_f32 v[110:111], v[118:119], v[122:123], v[110:111]
  v_pk_fma_f32 v[116:117], v[112:113], v[14:15], v[14:15] op_sel:[0,0,1] op_sel_hi:[1,0,1]
  v_pk_fma_f32 v[118:119], v[114:115], v[14:15], v[14:15] op_sel:[0,0,1] op_sel_hi:[1,0,1]
  v_lshlrev_b32 v120, 16, v94
  v_and_b32 v121, s64, v94
  v_lshlrev_b32 v122, 16, v95
  v_and_b32 v123, s64, v95
  v_pk_fma_f32 v[112:113], v[116:117], v[120:121], v[112:113]
  v_pk_fma_f32 v[114:115], v[118:119], v[122:123], v[114:115]
  v_cvt_pk_bf16_f32 v60, v108, v109
  v_cvt_pk_bf16_f32 v61, v110, v111
  v_cvt_pk_bf16_f32 v62, v112, v113
  v_cvt_pk_bf16_f32 v63, v114, v115
  ds_write_b128 v146, v[60:63] offset:41024
  v_dot2_f32_bf16 v124, v60, s62, v124
  v_dot2_f32_bf16 v125, v60, v60, v125
  v_dot2_f32_bf16 v124, v61, s62, v124
  v_dot2_f32_bf16 v125, v61, v61, v125
  v_dot2_f32_bf16 v124, v62, s62, v124
  v_dot2_f32_bf16 v125, v62, v62, v125
  v_dot2_f32_bf16 v124, v63, s62, v124
  v_dot2_f32_bf16 v125, v63, v63, v125
  v_lshlrev_b32 v108, 16, v64
  v_and_b32 v109, s64, v64
  s_waitcnt vmcnt(1)
  s_add_u32 s81, s76, 0
  s_mov_b64 exec, 1
  buffer_store_dwordx2 v[4:5], v0, s[40:43], s81 offen sc1
  s_mov_b64 exec, -1
  v_lshlrev_b32 v110, 16, v65
  v_and_b32 v111, s64, v65
  v_lshlrev_b32 v112, 16, v66
  v_and_b32 v113, s64, v66
  v_lshlrev_b32 v114, 16, v67
  v_and_b32 v115, s64, v67
  v_pk_fma_f32 v[116:117], v[108:109], v[14:15], v[14:15] op_sel:[0,0,1] op_sel_hi:[1,0,1]
  v_pk_fma_f32 v[118:119], v[110:111], v[14:15], v[14:15] op_sel:[0,0,1] op_sel_hi:[1,0,1]
  v_lshlrev_b32 v120, 16, v96
  v_and_b32 v121, s64, v96
  s_add_u32 m0, s59, 90112
  s_add_u32 s13, s57, 27648
  buffer_load_dwordx4 v2, s[40:43], s13 offen sc1 lds
  v_lshlrev_b32 v122, 16, v97
  v_and_b32 v123, s64, v97
  v_pk_fma_f32 v[108:109], v[116:117], v[120:121], v[108:109]
  v_pk_fma_f32 v[110:111], v[118:119], v[122:123], v[110:111]
  v_pk_fma_f32 v[116:117], v[112:113], v[14:15], v[14:15] op_sel:[0,0,1] op_sel_hi:[1,0,1]
  v_pk_fma_f32 v[118:119], v[114:115], v[14:15], v[14:15] op_sel:[0,0,1] op_sel_hi:[1,0,1]
  v_lshlrev_b32 v120, 16, v98
  v_and_b32 v121, s64, v98
  v_lshlrev_b32 v122, 16, v99
  v_and_b32 v123, s64, v99
  v_pk_fma_f32 v[112:113], v[116:117], v[120:121], v[112:113]
  v_pk_fma_f32 v[114:115], v[118:119], v[122:123], v[114:115]
  v_cvt_pk_bf16_f32 v64, v108, v109
  v_cvt_pk_bf16_f32 v65, v110, v111
  v_cvt_pk_bf16_f32 v66, v112, v113
  v_cvt_pk_bf16_f32 v67, v114, v115
  s_add_u32 m0, s59, 91136
  s_add_u32 s13, s57, 142336
  buffer_load_dwordx4 v2, s[40:43], s13 offen sc1 lds
  ds_write_b128 v146, v[64:67] offset:45120
  v_dot2_f32_bf16 v124, v64, s62, v124
  v_dot2_f32_bf16 v125, v64, v64, v125
  v_dot2_f32_bf16 v124, v65, s62, v124
  v_dot2_f32_bf16 v125, v65, v65, v125
  v_dot2_f32_bf16 v124, v66, s62, v124
  v_dot2_f32_bf16 v125, v66, v66, v125
  v_dot2_f32_bf16 v124, v67, s62, v124
  v_dot2_f32_bf16 v125, v67, v67, v125
  v_lshlrev_b32 v108, 16, v68
  v_and_b32 v109, s64, v68
  v_lshlrev_b32 v110, 16, v69
  v_and_b32 v111, s64, v69
  v_lshlrev_b32 v112, 16, v70
  v_and_b32 v113, s64, v70
  v_lshlrev_b32 v114, 16, v71
  s_add_u32 s13, s57, 12288
  buffer_load_dwordx4 v[224:227], v2, s[40:43], s13 offen offset:0 sc1
  v_and_b32 v115, s64, v71
  v_pk_fma_f32 v[116:117], v[108:109], v[14:15], v[14:15] op_sel:[0,0,1] op_sel_hi:[1,0,1]
  v_pk_fma_f32 v[118:119], v[110:111], v[14:15], v[14:15] op_sel:[0,0,1] op_sel_hi:[1,0,1]
  v_lshlrev_b32 v120, 16, v100
  v_and_b32 v121, s64, v100
  v_lshlrev_b32 v122, 16, v101
  v_and_b32 v123, s64, v101
  v_pk_fma_f32 v[108:109], v[116:117], v[120:121], v[108:109]
  v_pk_fma_f32 v[110:111], v[118:119], v[122:123], v[110:111]
  v_pk_fma_f32 v[116:117], v[112:113], v[14:15], v[14:15] op_sel:[0,0,1] op_sel_hi:[1,0,1]
  v_pk_fma_f32 v[118:119], v[114:115], v[14:15], v[14:15] op_sel:[0,0,1] op_sel_hi:[1,0,1]
  v_lshlrev_b32 v120, 16, v102
  v_and_b32 v121, s64, v102
  v_lshlrev_b32 v122, 16, v103
  v_and_b32 v123, s64, v103
  v_pk_fma_f32 v[112:113], v[116:117], v[120:121], v[112:113]
  s_add_u32 s13, s57, 126976
  buffer_load_dwordx4 v[228:231], v2, s[40:43], s13 offen offset:0 sc1
  v_pk_fma_f32 v[114:115], v[118:119], v[122:123], v[114:115]
  v_cvt_pk_bf16_f32 v68, v108, v109
  v_cvt_pk_bf16_f32 v69, v110, v111
  v_cvt_pk_bf16_f32 v70, v112, v113
  v_cvt_pk_bf16_f32 v71, v114, v115
  ds_write_b128 v146, v[68:71] offset:49216
  v_dot2_f32_bf16 v124, v68, s62, v124
  v_dot2_f32_bf16 v125, v68, v68, v125
  v_dot2_f32_bf16 v124, v69, s62, v124
  v_dot2_f32_bf16 v125, v69, v69, v125
  v_dot2_f32_bf16 v124, v70, s62, v124
  v_dot2_f32_bf16 v125, v70, v70, v125
  v_dot2_f32_bf16 v124, v71, s62, v124
  v_dot2_f32_bf16 v125, v71, v71, v125
  v_lshlrev_b32 v108, 16, v72
  v_and_b32 v109, s64, v72
  s_add_u32 s13, s57, 12288
  buffer_load_dwordx4 v[232:235], v2, s[40:43], s13 offen offset:1024 sc1
  v_lshlrev_b32 v110, 16, v73
  v_and_b32 v111, s64, v73
  v_lshlrev_b32 v112, 16, v74
  v_and_b32 v113, s64, v74
  v_lshlrev_b32 v114, 16, v75
  v_and_b32 v115, s64, v75
  v_pk_fma_f32 v[116:117], v[108:109], v[14:15], v[14:15] op_sel:[0,0,1] op_sel_hi:[1,0,1]
  v_pk_fma_f32 v[118:119], v[110:111], v[14:15], v[14:15] op_sel:[0,0,1] op_sel_hi:[1,0,1]
  v_lshlrev_b32 v120, 16, v104
  v_and_b32 v121, s64, v104
  v_lshlrev_b32 v122, 16, v105
  v_and_b32 v123, s64, v105
  v_pk_fma_f32 v[108:109], v[116:117], v[120:121], v[108:109]
  v_pk_fma_f32 v[110:111], v[118:119], v[122:123], v[110:111]
  v_pk_fma_f32 v[116:117], v[112:113], v[14:15], v[14:15] op_sel:[0,0,1] op_sel_hi:[1,0,1]
  v_pk_fma_f32 v[118:119], v[114:115], v[14:15], v[14:15] op_sel:[0,0,1] op_sel_hi:[1,0,1]
  s_add_u32 s13, s57, 126976
  buffer_load_dwordx4 v[236:239], v2, s[40:43], s13 offen offset:1024 sc1
  v_lshlrev_b32 v120, 16, v106
  v_and_b32 v121, s64, v106
  v_lshlrev_b32 v122, 16, v107
  v_and_b32 v123, s64, v107
  v_pk_fma_f32 v[112:113], v[116:117], v[120:121], v[112:113]
  v_pk_fma_f32 v[114:115], v[118:119], v[122:123], v[114:115]
  v_cvt_pk_bf16_f32 v72, v108, v109
  v_cvt_pk_bf16_f32 v73, v110, v111
  v_cvt_pk_bf16_f32 v74, v112, v113
  v_cvt_pk_bf16_f32 v75, v114, v115
  ds_write_b128 v146, v[72:75] offset:53312
  v_dot2_f32_bf16 v124, v72, s62, v124
  v_dot2_f32_bf16 v125, v72, v72, v125
  v_dot2_f32_bf16 v124, v73, s62, v124
  v_dot2_f32_bf16 v125, v73, v73, v125
  v_dot2_f32_bf16 v124, v74, s62, v124
  s_add_u32 s13, s57, 12288
  buffer_load_dwordx4 v[240:243], v2, s[40:43], s13 offen offset:2048 sc1
  v_dot2_f32_bf16 v125, v74, v74, v125
  v_dot2_f32_bf16 v124, v75, s62, v124
  v_dot2_f32_bf16 v125, v75, v75, v125
  s_nop 1
  v_add_f32 v124, v124, v124 row_ror:8
  v_add_f32 v125, v125, v125 row_ror:8
  v_mov_b32 v126, v124
  v_mov_b32 v127, v125
  s_nop 0
  v_permlane16_swap_b32 v124, v126
  v_permlane16_swap_b32 v125, v127
  v_add_f32 v124, v124, v126
  v_add_f32 v125, v125, v127
  v_mov_b32 v126, v124
  v_mov_b32 v127, v125
  s_nop 0
  v_permlane32_swap_b32 v124, v126
  v_permlane32_swap_b32 v125, v127
  v_add_f32 v124, v124, v126
  s_add_u32 s13, s57, 126976
  buffer_load_dwordx4 v[244:247], v2, s[40:43], s13 offen offset:2048 sc1
  v_add_f32 v125, v125, v127
  v_mul_f32 v124, s63, v124
  v_mul_f32 v126, v124, v124
  v_fma_f32 v125, s63, v125, -v126
  v_max_f32 v125, 0, v125
  v_cvt_pk_bf16_f32 v125, v125, v125
  v_lshlrev_b32 v125, 16, v125
  v_add_f32 v125, 0x3727c5ac, v125
  v_cvt_pk_bf16_f32 v125, v125, v125
  v_lshlrev_b32 v125, 16, v125
  v_sqrt_f32 v125, v125
  s_nop 0
  v_cvt_pk_bf16_f32 v125, v125, v125
  v_lshlrev_b32 v125, 16, v125
  v_rcp_f32 v127, v125
  v_cvt_pk_bf16_f32 v124, v124, v124
  v_lshlrev_b32 v124, 16, v124
  s_add_u32 s13, s57, 12288
  buffer_load_dwordx4 v[248:251], v2, s[40:43], s13 offen offset:3072 sc1
  v_sub_f32 v126, 0, v124
  s_mov_b64 exec, 0xff
  ds_write_b64 v147, v[126:127] offset:256
  s_mov_b64 exec, -1
  s_waitcnt lgkmcnt(0)
  s_barrier
  ds_read_b128 v[132:135], v148 offset:28736
  ds_read_b128 v[136:139], v148 offset:29760
  ds_read_b128 v[12:15], v149 offset:28736
  ds_read_b64 v[158:159], v150 offset:256
  ds_read_b128 v[140:143], v148 offset:30784
  s_waitcnt lgkmcnt(4)
  v_mfma_f32_32x32x16_bf16 v[48:63], a[0:3], v[132:135], 0
  s_add_u32 s13, s57, 126976
  buffer_load_dwordx4 v[252:255], v2, s[40:43], s13 offen offset:3072 sc1
  ds_read_b128 v[132:135], v148 offset:31808
  s_waitcnt lgkmcnt(4)
  v_mfma_f32_32x32x16_bf16 v[48:63], a[8:11], v[136:139], v[48:63]
  ds_read_b128 v[136:139], v148 offset:32832
  s_waitcnt lgkmcnt(2)
  v_mfma_f32_32x32x16_bf16 v[48:63], a[16:19], v[140:143], v[48:63]
  s_add_u32 m0, s59, 0
  s_add_u32 s13, s57, 16384
  buffer_load_dwordx4 v2, s[40:43], s13 offen sc1 lds
  ds_read_b128 v[140:143], v148 offset:33856
  s_waitcnt lgkmcnt(2)
  v_mfma_f32_32x32x16_bf16 v[48:63], a[24:27], v[132:135], v[48:63]
  ds_read_b128 v[132:135], v148 offset:34880
  s_waitcnt lgkmcnt(2)
  v_mfma_f32_32x32x16_bf16 v[48:63], a[32:35], v[136:139], v[48:63]
  s_add_u32 m0, s59, 1024
  s_add_u32 s13, s57, 131072
  buffer_load_dwordx4 v2, s[40:43], s13 offen sc1 lds
  ds_read_b128 v[136:139], v148 offset:35904
  s_waitcnt lgkmcnt(2)
  v_mfma_f32_32x32x16_bf16 v[48:63], a[40:43], v[140:143], v[48:63]
  ds_read_b128 v[140:143], v148 offset:36928
  s_waitcnt lgkmcnt(2)
  v_mfma_f32_32x32x16_bf16 v[48:63], a[48:51], v[132:135], v[48:63]
  s_add_u32 m0, s59, 8192
  s_add_u32 s13, s57, 17408
  buffer_load_dwordx4 v2, s[40:43], s13 offen sc1 lds
  ds_read_b128 v[132:135], v148 offset:37952
  s_waitcnt lgkmcnt(2)
  v_mfma_f32_32x32x16_bf16 v[48:63], a[56:59], v[136:139], v[48:63]
  ds_read_b128 v[136:139], v148 offset:38976
  s_waitcnt lgkmcnt(2)
  v_mfma_f32_32x32x16_bf16 v[48:63], a[64:67], v[140:143], v[48:63]
  s_add_u32 m0, s59, 9216
  s_add_u32 s13, s57, 132096
  buffer_load_dwordx4 v2, s[40:43], s13 offen sc1 lds
  ds_read_b128 v[140:143], v148 offset:40000
  s_waitcnt lgkmcnt(2)
  v_mfma_f32_32x32x16_bf16 v[48:63], a[72:75], v[132:135], v[48:63]
  ds_read_b128 v[132:135], v148 offset:41024
  s_waitcnt lgkmcnt(2)
  v_mfma_f32_32x32x16_bf16 v[48:63], a[80:83], v[136:139], v[48:63]
  s_add_u32 m0, s59, 16384
  s_add_u32 s13, s57, 18432
  buffer_load_dwordx4 v2, s[40:43], s13 offen sc1 lds
  ds_read_b128 v[136:139], v148 offset:42048
  s_waitcnt lgkmcnt(2)
  v_mfma_f32_32x32x16_bf16 v[48:63], a[88:91], v[140:143], v[48:63]
  ds_read_b128 v[140:143], v148 offset:43072
  s_waitcnt lgkmcnt(2)
  v_mfma_f32_32x32x16_bf16 v[48:63], a[96:99], v[132:135], v[48:63]
  s_add_u32 m0, s59, 17408
  s_add_u32 s13, s57, 133120
  buffer_load_dwordx4 v2, s[40:43], s13 offen sc1 lds
  ds_read_b128 v[132:135], v148 offset:44096
  s_waitcnt lgkmcnt(2)
  v_mfma_f32_32x32x16_bf16 v[48:63], a[104:107], v[136:139], v[48:63]
  ds_read_b128 v[136:139], v148 offset:45120
  s_waitcnt lgkmcnt(2)
  v_mfma_f32_32x32x16_bf16 v[48:63], a[112:115], v[140:143], v[48:63]
  s_add_u32 m0, s59, 24576
  s_add_u32 s13, s57, 19456
  buffer_load_dwordx4 v2, s[40:43], s13 offen sc1 lds
  ds_read_b128 v[140:143], v148 offset:46144
  s_waitcnt lgkmcnt(2)
  v_mfma_f32_32x32x16_bf16 v[48:63], a[120:123], v[132:135], v[48:63]
  ds_read_b128 v[132:135], v148 offset:47168
  s_waitcnt lgkmcnt(2)
  v_mfma_f32_32x32x16_bf16 v[48:63], a[128:131], v[136:139], v[48:63]
  s_add_u32 m0, s59, 25600
  s_add_u32 s13, s57, 134144
  buffer_load_dwordx4 v2, s[40:43], s13 offen sc1 lds
  ds_read_b128 v[136:139], v148 offset:48192
  s_waitcnt lgkmcnt(2)
  v_mfma_f32_32x32x16_bf16 v[48:63], a[136:139], v[140:143], v[48:63]
  ds_read_b128 v[140:143], v148 offset:49216
  s_waitcnt lgkmcnt(2)
  v_mfma_f32_32x32x16_bf16 v[48:63], a[144:147], v[132:135], v[48:63]
  s_add_u32 m0, s59, 32768
  s_add_u32 s13, s57, 20480
  buffer_load_dwordx4 v2, s[40:43], s13 offen sc1 lds
  ds_read_b128 v[132:135], v148 offset:50240
  s_waitcnt lgkmcnt(2)
  v_mfma_f32_32x32x16_bf16 v[48:63], a[152:155], v[136:139], v[48:63]
  ds_read_b128 v[136:139], v148 offset:51264
  s_waitcnt lgkmcnt(2)
  v_mfma_f32_32x32x16_bf16 v[48:63], a[160:163], v[140:143], v[48:63]
  s_add_u32 s82, s69, 0
  buffer_load_dwordx2 v[126:127], v145, s[40:43], s82 offen sc1
  s_add_u32 m0, s59, 33792
  s_add_u32 s13, s57, 135168
  buffer_load_dwordx4 v2, s[40:43], s13 offen sc1 lds
  ds_read_b128 v[140:143], v148 offset:52288
  s_waitcnt lgkmcnt(2)
  v_mfma_f32_32x32x16_bf16 v[48:63], a[168:171], v[132:135], v[48:63]
  ds_read_b128 v[132:135], v148 offset:53312
  s_waitcnt lgkmcnt(2)
  v_mfma_f32_32x32x16_bf16 v[48:63], a[176:179], v[136:139], v[48:63]
  s_add_u32 m0, s59, 40960
  s_add_u32 s13, s57, 21504
  buffer_load_dwordx4 v2, s[40:43], s13 offen sc1 lds
  ds_read_b128 v[136:139], v148 offset:54336
  s_waitcnt lgkmcnt(2)
  v_mfma_f32_32x32x16_bf16 v[48:63], a[184:187], v[140:143], v[48:63]
  ds_read_b128 v[140:143], v148 offset:55360
  s_waitcnt lgkmcnt(2)
  v_mfma_f32_32x32x16_bf16 v[48:63], a[192:195], v[132:135], v[48:63]
  s_add_u32 m0, s59, 41984
  s_add_u32 s13, s57, 136192
  buffer_load_dwordx4 v2, s[40:43], s13 offen sc1 lds
  ds_read_b128 v[132:135], v148 offset:56384
  s_waitcnt lgkmcnt(2)
  v_mfma_f32_32x32x16_bf16 v[48:63], a[200:203], v[136:139], v[48:63]
  ds_read_b128 v[136:139], v148 offset:28736
  s_waitcnt lgkmcnt(2)
  v_mfma_f32_32x32x16_bf16 v[48:63], a[208:211], v[140:143], v[48:63]
  s_add_u32 m0, s59, 49152
  s_add_u32 s13, s57, 22528
  buffer_load_dwordx4 v2, s[40:43], s13 offen sc1 lds
  ds_read_b128 v[140:143], v148 offset:29760
  s_waitcnt lgkmcnt(2)
  v_mfma_f32_32x32x16_bf16 v[48:63], a[216:219], v[132:135], v[48:63]
  ds_read_b128 v[132:135], v148 offset:30784
  s_waitcnt lgkmcnt(2)
  v_mfma_f32_32x32x16_bf16 v[64:79], a[4:7], v[136:139], 0
  s_add_u32 m0, s59, 50176
  s_add_u32 s13, s57, 137216
  buffer_load_dwordx4 v2, s[40:43], s13 offen sc1 lds
  ds_read_b128 v[136:139], v148 offset:31808
  s_waitcnt lgkmcnt(2)
  v_mfma_f32_32x32x16_bf16 v[64:79], a[12:15], v[140:143], v[64:79]
  s_add_u32 s73, s75, 16891904
  ds_read_b128 v[108:111], v151 offset:0
  ds_read_b128 v[112:115], v151 offset:16
  s_waitcnt lgkmcnt(0)
  ds_read_b128 v[140:143], v148 offset:32832
  v_mfma_f32_32x32x16_bf16 v[64:79], a[20:23], v[132:135], v[64:79]
  v_fmac_f32 v48, v108, v158
  v_fmac_f32 v49, v109, v158
  v_fmac_f32 v50, v110, v158
  v_fmac_f32 v51, v111, v158
  s_add_u32 m0, s59, 57344
  s_add_u32 s13, s57, 23552
  buffer_load_dwordx4 v2, s[40:43], s13 offen sc1 lds
  ds_read_b128 v[132:135], v148 offset:33856
  v_mfma_f32_32x32x16_bf16 v[64:79], a[28:31], v[136:139], v[64:79]
  v_fmac_f32 v52, v112, v158
  v_fmac_f32 v53, v113, v158
  v_fmac_f32 v54, v114, v158
  v_fmac_f32 v55, v115, v158
  ds_read_b128 v[136:139], v148 offset:34880
  s_waitcnt lgkmcnt(2)
  v_mfma_f32_32x32x16_bf16 v[64:79], a[36:39], v[140:143], v[64:79]
  ds_read_b128 v[108:111], v151 offset:32
  ds_read_b128 v[112:115], v151 offset:48
  s_waitcnt lgkmcnt(0)
  v_fmac_f32 v56, v108, v158
  s_add_u32 m0, s59, 58368
  s_add_u32 s13, s57, 138240
  buffer_load_dwordx4 v2, s[40:43], s13 offen sc1 lds
  ds_read_b128 v[140:143], v148 offset:35904
  v_mfma_f32_32x32x16_bf16 v[64:79], a[44:47], v[132:135], v[64:79]
  v_fmac_f32 v57, v109, v158
  v_fmac_f32 v58, v110, v158
  v_fmac_f32 v59, v111, v158
  v_fmac_f32 v60, v112, v158
  ds_read_b128 v[132:135], v148 offset:36928
  v_mfma_f32_32x32x16_bf16 v[64:79], a[52:55], v[136:139], v[64:79]
  v_fmac_f32 v61, v113, v158
  v_fmac_f32 v62, v114, v158
  v_fmac_f32 v63, v115, v158
  v_max_f32 v48, 0, v48
  ds_read_b128 v[136:139], v148 offset:37952
  s_waitcnt lgkmcnt(2)
  v_mfma_f32_32x32x16_bf16 v[64:79], a[60:63], v[140:143], v[64:79]
  v_max_f32 v49, 0, v49
  v_max_f32 v50, 0, v50
  v_max_f32 v51, 0, v51
  v_max_f32 v52, 0, v52
  ds_read_b128 v[140:143], v148 offset:38976
  s_waitcnt lgkmcnt(2)
  v_mfma_f32_32x32x16_bf16 v[64:79], a[68:71], v[132:135], v[64:79]
  v_max_f32 v53, 0, v53
  v_max_f32 v54, 0, v54
  v_max_f32 v55, 0, v55
  v_max_f32 v56, 0, v56
  ds_read_b128 v[132:135], v148 offset:40000
  s_waitcnt lgkmcnt(2)
  v_mfma_f32_32x32x16_bf16 v[64:79], a[76:79], v[136:139], v[64:79]
  v_max_f32 v57, 0, v57
  v_max_f32 v58, 0, v58
  v_max_f32 v59, 0, v59
  v_max_f32 v60, 0, v60
  ds_read_b128 v[136:139], v148 offset:41024
  s_waitcnt lgkmcnt(2)
  v_mfma_f32_32x32x16_bf16 v[64:79], a[84:87], v[140:143], v[64:79]
  v_max_f32 v61, 0, v61
  v_max_f32 v62, 0, v62
  v_max_f32 v63, 0, v63
  v_cvt_pk_bf16_f32 v48, v48, v49
  ds_read_b128 v[140:143], v148 offset:42048
  s_waitcnt lgkmcnt(2)
  v_mfma_f32_32x32x16_bf16 v[64:79], a[92:95], v[132:135], v[64:79]
  v_cvt_pk_bf16_f32 v49, v50, v51
  v_cvt_pk_bf16_f32 v50, v52, v53
  v_cvt_pk_bf16_f32 v51, v54, v55
  v_cvt_pk_bf16_f32 v52, v56, v57
  ds_read_b128 v[132:135], v148 offset:43072
  s_waitcnt lgkmcnt(2)
  v_mfma_f32_32x32x16_bf16 v[64:79], a[100:103], v[136:139], v[64:79]
  v_cvt_pk_bf16_f32 v53, v58, v59
  v_cvt_pk_bf16_f32 v54, v60, v61
  v_cvt_pk_bf16_f32 v55, v62, v63
  buffer_store_dwordx4 v[48:51], v2, s[40:43], s73 offen offset:0 sc1
  ds_read_b128 v[136:139], v148 offset:44096
  s_waitcnt lgkmcnt(2)
  v_mfma_f32_32x32x16_bf16 v[64:79], a[108:111], v[140:143], v[64:79]
  buffer_store_dwordx4 v[52:55], v2, s[40:43], s73 offen offset:1024 sc1
  ds_read_b128 v[140:143], v148 offset:45120
  s_waitcnt lgkmcnt(2)
  v_mfma_f32_32x32x16_bf16 v[64:79], a[116:119], v[132:135], v[64:79]
  ds_read_b128 v[132:135], v148 offset:46144
  s_waitcnt lgkmcnt(2)
  v_mfma_f32_32x32x16_bf16 v[64:79], a[124:127], v[136:139], v[64:79]
  ds_read_b128 v[136:139], v148 offset:47168
  s_waitcnt lgkmcnt(2)
  v_mfma_f32_32x32x16_bf16 v[64:79], a[132:135], v[140:143], v[64:79]
  ds_read_b128 v[140:143], v148 offset:48192
  s_waitcnt lgkmcnt(2)
  v_mfma_f32_32x32x16_bf16 v[64:79], a[140:143], v[132:135], v[64:79]
  ds_read_b128 v[132:135], v148 offset:49216
  s_waitcnt lgkmcnt(2)
  v_mfma_f32_32x32x16_bf16 v[64:79], a[148:151], v[136:139], v[64:79]
  ds_read_b128 v[136:139], v148 offset:50240
  s_waitcnt lgkmcnt(2)
  v_mfma_f32_32x32x16_bf16 v[64:79], a[156:159], v[140:143], v[64:79]
  ds_read_b128 v[140:143], v148 offset:51264
  s_waitcnt lgkmcnt(2)
  v_mfma_f32_32x32x16_bf16 v[64:79], a[164:167], v[132:135], v[64:79]
  ds_read_b128 v[132:135], v148 offset:52288
  s_waitcnt lgkmcnt(2)
  v_mfma_f32_32x32x16_bf16 v[64:79], a[172:175], v[136:139], v[64:79]
  ds_read_b128 v[136:139], v148 offset:53312
  s_waitcnt lgkmcnt(2)
  v_mfma_f32_32x32x16_bf16 v[64:79], a[180:183], v[140:143], v[64:79]
  ds_read_b128 v[140:143], v148 offset:54336
  s_waitcnt lgkmcnt(2)
  v_mfma_f32_32x32x16_bf16 v[64:79], a[188:191], v[132:135], v[64:79]
  ds_read_b128 v[132:135], v148 offset:55360
  s_waitcnt lgkmcnt(2)
  v_mfma_f32_32x32x16_bf16 v[64:79], a[196:199], v[136:139], v[64:79]
  ds_read_b128 v[136:139], v148 offset:56384
  s_waitcnt lgkmcnt(2)
  v_mfma_f32_32x32x16_bf16 v[64:79], a[204:207], v[140:143], v[64:79]
  s_waitcnt lgkmcnt(1)
  v_mfma_f32_32x32x16_bf16 v[64:79], a[212:215], v[132:135], v[64:79]
  s_waitcnt lgkmcnt(0)
  v_mfma_f32_32x32x16_bf16 v[64:79], a[220:223], v[136:139], v[64:79]
  s_add_u32 s73, s75, 16891904
  ds_read_b128 v[108:111], v151 offset:128
  ds_read_b128 v[112:115], v151 offset:144
  s_waitcnt lgkmcnt(0)
  s_nop 7
  v_fmac_f32 v64, v108, v158
  v_fmac_f32 v65, v109, v158
  v_fmac_f32 v66, v110, v158
  v_fmac_f32 v67, v111, v158
  v_fmac_f32 v68, v112, v158
  v_fmac_f32 v69, v113, v158
  v_fmac_f32 v70, v114, v158
  v_fmac_f32 v71, v115, v158
  ds_read_b128 v[108:111], v151 offset:160
  ds_read_b128 v[112:115], v151 offset:176
  s_waitcnt lgkmcnt(0)
  v_fmac_f32 v72, v108, v158
  v_fmac_f32 v73, v109, v158
  v_fmac_f32 v74, v110, v158
  v_fmac_f32 v75, v111, v158
  v_fmac_f32 v76, v112, v158
  v_fmac_f32 v77, v113, v158
  v_fmac_f32 v78, v114, v158
  v_fmac_f32 v79, v115, v158
  v_cvt_pk_bf16_f32 v64, v64, v65
  v_cvt_pk_bf16_f32 v65, v66, v67
  v_cvt_pk_bf16_f32 v66, v68, v69
  v_cvt_pk_bf16_f32 v67, v70, v71
  v_cvt_pk_bf16_f32 v68, v72, v73
  v_cvt_pk_bf16_f32 v69, v74, v75
  v_cvt_pk_bf16_f32 v70, v76, v77
  v_cvt_pk_bf16_f32 v71, v78, v79
  v_pk_max_i16 v64, v64, 0
  v_pk_max_i16 v65, v65, 0
  v_pk_max_i16 v66, v66, 0
  v_pk_max_i16 v67, v67, 0
  v_pk_max_i16 v68, v68, 0
  v_pk_max_i16 v69, v69, 0
  v_pk_max_i16 v70, v70, 0
  v_pk_max_i16 v71, v71, 0
  buffer_store_dwordx4 v[64:67], v2, s[40:43], s73 offen offset:2048 sc1
  buffer_store_dwordx4 v[68:71], v2, s[40:43], s73 offen offset:3072 sc1
  s_waitcnt vmcnt(11)
PH00:
  v_xor_b32 v126, s66, v126
  v_xor_b32 v127, s67, v127
  v_or_b32 v126, v126, v127
  v_cmp_ne_u32 vcc, 0, v126
  s_nop 0
  s_cbranch_vccz PH00_D
  s_add_u32 s83, s83, 1
  s_cmp_gt_u32 s83, 0x40000
  s_cbranch_scc1 PH00_D
  s_sleep 4
  buffer_load_dwordx2 v[126:127], v145, s[40:43], s82 offen sc1
  s_waitcnt vmcnt(0)
  s_branch PH00
PH00_D:
  s_add_u32 s70, s77, 16777216
  buffer_load_dwordx4 v[96:99], v2, s[40:43], s70 offen offset:0 sc1
  s_add_u32 s70, s77, 16777216
  buffer_load_dwordx4 v[100:103], v2, s[40:43], s70 offen offset:1024 sc1
  s_add_u32 s70, s77, 16777216
  buffer_load_dwordx4 v[104:107], v2, s[40:43], s70 offen offset:2048 sc1
  s_add_u32 s70, s77, 16777216
  buffer_load_dwordx4 v[108:111], v2, s[40:43], s70 offen offset:3072 sc1
  s_add_u32 s70, s77, 16781312
  buffer_load_dwordx4 v[112:115], v2, s[40:43], s70 offen offset:0 sc1
  s_add_u32 s70, s77, 16781312
  buffer_load_dwordx4 v[116:119], v2, s[40:43], s70 offen offset:1024 sc1
  s_add_u32 s70, s77, 16781312
  buffer_load_dwordx4 v[120:123], v2, s[40:43], s70 offen offset:2048 sc1
  s_add_u32 s70, s77, 16781312
  buffer_load_dwordx4 v[80:83], v2, s[40:43], s70 offen offset:3072 sc1
  s_add_u32 s70, s77, 16785408
  buffer_load_dwordx4 v[84:87], v2, s[40:43], s70 offen offset:0 sc1
  s_add_u32 s70, s77, 16785408
  buffer_load_dwordx4 v[88:91], v2, s[40:43], s70 offen offset:1024 sc1
  s_add_u32 s70, s77, 16785408
  buffer_load_dwordx4 v[92:95], v2, s[40:43], s70 offen offset:2048 sc1
  s_add_u32 s70, s77, 16785408
  buffer_load_dwordx4 v[140:143], v2, s[40:43], s70 offen offset:3072 sc1
  s_waitcnt vmcnt(11)
  v_mfma_f32_32x32x16_bf16 v[16:31], a[224:227], v[96:99], 0
  s_add_u32 s81, s76, 8192
  s_mov_b64 exec, 1
  buffer_store_dwordx2 v[4:5], v0, s[40:43], s81 offen sc1
  s_mov_b64 exec, -1
  v_mfma_f32_32x32x16_bf16 v[32:47], a[228:231], v[96:99], 0
  s_add_u32 s70, s77, 16789504
  buffer_load_dwordx4 v[96:99], v2, s[40:43], s70 offen offset:0 sc1
  s_waitcnt vmcnt(12)
  v_mfma_f32_32x32x16_bf16 v[16:31], a[232:235], v[100:103], v[16:31]
  v_mfma_f32_32x32x16_bf16 v[32:47], a[236:239], v[100:103], v[32:47]
  s_add_u32 s70, s77, 16789504
  buffer_load_dwordx4 v[100:103], v2, s[40:43], s70 offen offset:1024 sc1
  s_waitcnt vmcnt(12)
  v_mfma_f32_32x32x16_bf16 v[16:31], a[240:243], v[104:107], v[16:31]
  v_mfma_f32_32x32x16_bf16 v[32:47], a[244:247], v[104:107], v[32:47]
  s_add_u32 s70, s77, 16789504
  buffer_load_dwordx4 v[104:107], v2, s[40:43], s70 offen offset:2048 sc1
  s_waitcnt vmcnt(12)
  v_mfma_f32_32x32x16_bf16 v[16:31], a[248:251], v[108:111], v[16:31]
  v_mfma_f32_32x32x16_bf16 v[32:47], a[252:255], v[108:111], v[32:47]
  s_add_u32 s70, s77, 16789504
  buffer_load_dwordx4 v[108:111], v2, s[40:43], s70 offen offset:3072 sc1
  s_waitcnt vmcnt(12)
  v_mfma_f32_32x32x16_bf16 v[16:31], v[160:163], v[112:115], v[16:31]
  v_mfma_f32_32x32x16_bf16 v[32:47], v[164:167], v[112:115], v[32:47]
  s_add_u32 s70, s77, 16793600
  buffer_load_dwordx4 v[112:115], v2, s[40:43], s70 offen offset:0 sc1
  s_waitcnt vmcnt(12)
  v_mfma_f32_32x32x16_bf16 v[16:31], v[168:171], v[116:119], v[16:31]
  v_mfma_f32_32x32x16_bf16 v[32:47], v[172:175], v[116:119], v[32:47]
  s_add_u32 s70, s77, 16793600
  buffer_load_dwordx4 v[116:119], v2, s[40:43], s70 offen offset:1024 sc1
  s_waitcnt vmcnt(12)
  v_mfma_f32_32x32x16_bf16 v[16:31], v[176:179], v[120:123], v[16:31]
  v_mfma_f32_32x32x16_bf16 v[32:47], v[180:183], v[120:123], v[32:47]
  s_add_u32 s70, s77, 16793600
  buffer_load_dwordx4 v[120:123], v2, s[40:43], s70 offen offset:2048 sc1
  s_waitcnt vmcnt(12)
  v_mfma_f32_32x32x16_bf16 v[16:31], v[184:187], v[80:83], v[16:31]
  v_mfma_f32_32x32x16_bf16 v[32:47], v[188:191], v[80:83], v[32:47]
  s_add_u32 s70, s77, 16793600
  buffer_load_dwordx4 v[80:83], v2, s[40:43], s70 offen offset:3072 sc1
  s_waitcnt vmcnt(12)
  v_mfma_f32_32x32x16_bf16 v[16:31], v[192:195], v[84:87], v[16:31]
  v_mfma_f32_32x32x16_bf16 v[32:47], v[196:199], v[84:87], v[32:47]
  s_add_u32 s70, s77, 16797696
  buffer_load_dwordx4 v[84:87], v2, s[40:43], s70 offen offset:0 sc1
  s_waitcnt vmcnt(12)
  v_mfma_f32_32x32x16_bf16 v[16:31], v[200:203], v[88:91], v[16:31]
  v_mfma_f32_32x32x16_bf16 v[32:47], v[204:207], v[88:91], v[32:47]
  s_add_u32 s70, s77, 16797696
  buffer_load_dwordx4 v[88:91], v2, s[40:43], s70 offen offset:1024 sc1
  s_waitcnt vmcnt(12)
  v_mfma_f32_32x32x16_bf16 v[16:31], v[208:211], v[92:95], v[16:31]
  v_mfma_f32_32x32x16_bf16 v[32:47], v[212:215], v[92:95], v[32:47]
  s_add_u32 s70, s77, 16797696
  buffer_load_dwordx4 v[92:95], v2, s[40:43], s70 offen offset:2048 sc1
  s_waitcnt vmcnt(12)
  v_mfma_f32_32x32x16_bf16 v[16:31], v[216:219], v[140:143], v[16:31]
  v_mfma_f32_32x32x16_bf16 v[32:47], v[220:223], v[140:143], v[32:47]
  s_add_u32 s70, s77, 16797696
  buffer_load_dwordx4 v[140:143], v2, s[40:43], s70 offen offset:3072 sc1
  s_waitcnt vmcnt(11)
  v_mfma_f32_32x32x16_bf16 v[16:31], v[224:227], v[96:99], v[16:31]
  v_mfma_f32_32x32x16_bf16 v[32:47], v[228:231], v[96:99], v[32:47]
  s_add_u32 s70, s77, 16801792
  buffer_load_dwordx4 v[96:99], v2, s[40:43], s70 offen offset:0 sc1
  s_waitcnt vmcnt(11)
  v_mfma_f32_32x32x16_bf16 v[16:31], v[232:235], v[100:103], v[16:31]
  v_mfma_f32_32x32x16_bf16 v[32:47], v[236:239], v[100:103], v[32:47]
  s_add_u32 s70, s77, 16801792
  buffer_load_dwordx4 v[100:103], v2, s[40:43], s70 offen offset:1024 sc1
  ds_read_b128 v[124:127], v152 offset:0
  ds_read_b128 v[128:131], v152 offset:1024
  s_waitcnt vmcnt(11)
  v_mfma_f32_32x32x16_bf16 v[16:31], v[240:243], v[104:107], v[16:31]
  v_mfma_f32_32x32x16_bf16 v[32:47], v[244:247], v[104:107], v[32:47]
  s_add_u32 s70, s77, 16801792
  buffer_load_dwordx4 v[104:107], v2, s[40:43], s70 offen offset:2048 sc1
  ds_read_b128 v[132:135], v152 offset:8192
  ds_read_b128 v[136:139], v152 offset:9216
  s_waitcnt vmcnt(11)
  v_mfma_f32_32x32x16_bf16 v[16:31], v[248:251], v[108:111], v[16:31]
  v_mfma_f32_32x32x16_bf16 v[32:47], v[252:255], v[108:111], v[32:47]
  s_add_u32 s70, s77, 16801792
  buffer_load_dwordx4 v[108:111], v2, s[40:43], s70 offen offset:3072 sc1
  s_waitcnt vmcnt(11) lgkmcnt(2)
  v_mfma_f32_32x32x16_bf16 v[16:31], v[124:127], v[112:115], v[16:31]
  v_mfma_f32_32x32x16_bf16 v[32:47], v[128:131], v[112:115], v[32:47]
  ds_read_b128 v[124:127], v152 offset:16384
  ds_read_b128 v[128:131], v152 offset:17408
  s_waitcnt vmcnt(10) lgkmcnt(2)
  v_mfma_f32_32x32x16_bf16 v[16:31], v[132:135], v[116:119], v[16:31]
  v_mfma_f32_32x32x16_bf16 v[32:47], v[136:139], v[116:119], v[32:47]
  ds_read_b128 v[132:135], v152 offset:24576
  ds_read_b128 v[136:139], v152 offset:25600
  s_waitcnt vmcnt(9) lgkmcnt(2)
  v_mfma_f32_32x32x16_bf16 v[16:31], v[124:127], v[120:123], v[16:31]
  s_add_u32 s82, s69, 8192
  buffer_load_dwordx2 v[76:77], v145, s[40:43], s82 offen sc1
  v_mfma_f32_32x32x16_bf16 v[32:47], v[128:131], v[120:123], v[32:47]
  ds_read_b128 v[124:127], v152 offset:32768
  ds_read_b128 v[128:131], v152 offset:33792
  s_waitcnt vmcnt(9) lgkmcnt(2)
  v_mfma_f32_32x32x16_bf16 v[16:31], v[132:135], v[80:83], v[16:31]
  v_mfma_f32_32x32x16_bf16 v[32:47], v[136:139], v[80:83], v[32:47]
  ds_read_b128 v[132:135], v152 offset:40960
  ds_read_b128 v[136:139], v152 offset:41984
  s_waitcnt vmcnt(8) lgkmcnt(2)
  v_mfma_f32_32x32x16_bf16 v[16:31], v[124:127], v[84:87], v[16:31]
  v_mfma_f32_32x32x16_bf16 v[32:47], v[128:131], v[84:87], v[32:47]
  ds_read_b128 v[124:127], v152 offset:49152
  ds_read_b128 v[128:131], v152 offset:50176
  s_waitcnt vmcnt(7) lgkmcnt(2)
  v_mfma_f32_32x32x16_bf16 v[16:31], v[132:135], v[88:91], v[16:31]
  v_mfma_f32_32x32x16_bf16 v[32:47], v[136:139], v[88:91], v[32:47]
  ds_read_b128 v[132:135], v152 offset:57344
  ds_read_b128 v[136:139], v152 offset:58368
  s_waitcnt vmcnt(6) lgkmcnt(2)
  v_mfma_f32_32x32x16_bf16 v[16:31], v[124:127], v[92:95], v[16:31]
  v_mfma_f32_32x32x16_bf16 v[32:47], v[128:131], v[92:95], v[32:47]
  v_add_u32 v152, 0x10000, v152
  ds_read_b128 v[124:127], v152 offset:0
  ds_read_b128 v[128:131], v152 offset:1024
  s_waitcnt vmcnt(5) lgkmcnt(2)
  v_mfma_f32_32x32x16_bf16 v[16:31], v[132:135], v[140:143], v[16:31]
  v_mfma_f32_32x32x16_bf16 v[32:47], v[136:139], v[140:143], v[32:47]
  ds_read_b128 v[132:135], v152 offset:8192
  ds_read_b128 v[136:139], v152 offset:9216
  s_waitcnt vmcnt(4) lgkmcnt(2)
  v_mfma_f32_32x32x16_bf16 v[16:31], v[124:127], v[96:99], v[16:31]
  v_mfma_f32_32x32x16_bf16 v[32:47], v[128:131], v[96:99], v[32:47]
  ds_read_b128 v[124:127], v152 offset:16384
  ds_read_b128 v[128:131], v152 offset:17408
  s_waitcnt vmcnt(3) lgkmcnt(2)
  v_mfma_f32_32x32x16_bf16 v[16:31], v[132:135], v[100:103], v[16:31]
  v_mfma_f32_32x32x16_bf16 v[32:47], v[136:139], v[100:103], v[32:47]
  ds_read_b128 v[132:135], v152 offset:24576
  ds_read_b128 v[136:139], v152 offset:25600
  s_waitcnt vmcnt(2) lgkmcnt(2)
  v_mfma_f32_32x32x16_bf16 v[16:31], v[124:127], v[104:107], v[16:31]
  v_mfma_f32_32x32x16_bf16 v[32:47], v[128:131], v[104:107], v[32:47]
  s_waitcnt vmcnt(1) lgkmcnt(0)
  v_mfma_f32_32x32x16_bf16 v[16:31], v[132:135], v[108:111], v[16:31]
  v_mfma_f32_32x32x16_bf16 v[32:47], v[136:139], v[108:111], v[32:47]
  v_subrev_u32 v152, 0x10000, v152
  s_cmp_lg_u32 s3, 0
  s_cbranch_scc1 E2_00_R1
  s_nop 7
  ds_write_b128 v148, v[24:27] offset:10240
  ds_write_b128 v148, v[28:31] offset:11264
  ds_write_b128 v148, v[32:35] offset:14336
  ds_write_b128 v148, v[36:39] offset:15360
  ds_write_b128 v148, v[40:43] offset:18432
  ds_write_b128 v148, v[44:47] offset:19456
  s_branch E2_00_RD
E2_00_R1:
  s_cmp_lg_u32 s3, 1
  s_cbranch_scc1 E2_00_R2
  s_nop 5
  ds_write_b128 v148, v[16:19] offset:0
  ds_write_b128 v148, v[20:23] offset:1024
  ds_write_b128 v148, v[32:35] offset:16384
  ds_write_b128 v148, v[36:39] offset:17408
  ds_write_b128 v148, v[40:43] offset:20480
  ds_write_b128 v148, v[44:47] offset:21504
  v_mov_b32 v16, v24
  v_mov_b32 v17, v25
  v_mov_b32 v18, v26
  v_mov_b32 v19, v27
  v_mov_b32 v20, v28
  v_mov_b32 v21, v29
  v_mov_b32 v22, v30
  v_mov_b32 v23, v31
  s_branch E2_00_RD
E2_00_R2:
  s_cmp_lg_u32 s3, 2
  s_cbranch_scc1 E2_00_R3
  s_nop 3
  ds_write_b128 v148, v[16:19] offset:2048
  ds_write_b128 v148, v[20:23] offset:3072
  ds_write_b128 v148, v[24:27] offset:6144
  ds_write_b128 v148, v[28:31] offset:7168
  ds_write_b128 v148, v[40:43] offset:22528
  ds_write_b128 v148, v[44:47] offset:23552
  v_mov_b32 v16, v32
  v_mov_b32 v17, v33
  v_mov_b32 v18, v34
  v_mov_b32 v19, v35
  v_mov_b32 v20, v36
  v_mov_b32 v21, v37
  v_mov_b32 v22, v38
  v_mov_b32 v23, v39
  s_branch E2_00_RD
E2_00_R3:
  s_nop 3
  ds_write_b128 v148, v[16:19] offset:4096
  ds_write_b128 v148, v[20:23] offset:5120
  ds_write_b128 v148, v[24:27] offset:8192
  ds_write_b128 v148, v[28:31] offset:9216
  ds_write_b128 v148, v[32:35] offset:12288
  ds_write_b128 v148, v[36:39] offset:13312
  v_mov_b32 v16, v40
  v_mov_b32 v17, v41
  v_mov_b32 v18, v42
  v_mov_b32 v19, v43
  v_mov_b32 v20, v44
  v_mov_b32 v21, v45
  v_mov_b32 v22, v46
  v_mov_b32 v23, v47
E2_00_RD:
  s_waitcnt vmcnt(0)
PH01:
  v_xor_b32 v76, s66, v76
  v_xor_b32 v77, s67, v77
  v_or_b32 v76, v76, v77
  v_cmp_ne_u32 vcc, 0, v76
  s_nop 0
  s_cbranch_vccz PH01_D
  s_add_u32 s83, s83, 1
  s_cmp_gt_u32 s83, 0x40000
  s_cbranch_scc1 PH01_D
  s_sleep 4
  buffer_load_dwordx2 v[76:77], v145, s[40:43], s82 offen sc1
  s_waitcnt vmcnt(0)
  s_branch PH01
PH01_D:
  s_waitcnt lgkmcnt(0)
  s_barrier
  ds_read_b128 v[24:27], v153 offset:0
  ds_read_b128 v[28:31], v153 offset:1024
  ds_read_b128 v[32:35], v153 offset:2048
  ds_read_b128 v[36:39], v153 offset:3072
  ds_read_b128 v[40:43], v153 offset:4096
  ds_read_b128 v[44:47], v153 offset:5120
  s_waitcnt lgkmcnt(4)
  v_pk_add_f32 v[16:17], v[16:17], v[24:25]
  v_pk_add_f32 v[18:19], v[18:19], v[26:27]
  v_pk_add_f32 v[20:21], v[20:21], v[28:29]
  v_pk_add_f32 v[22:23], v[22:23], v[30:31]
  s_waitcnt lgkmcnt(2)
  v_pk_add_f32 v[16:17], v[16:17], v[32:33]
  v_pk_add_f32 v[18:19], v[18:19], v[34:35]
  v_pk_add_f32 v[20:21], v[20:21], v[36:37]
  v_pk_add_f32 v[22:23], v[22:23], v[38:39]
  s_waitcnt lgkmcnt(0)
  v_pk_add_f32 v[16:17], v[16:17], v[40:41]
  v_pk_add_f32 v[18:19], v[18:19], v[42:43]
  v_pk_add_f32 v[20:21], v[20:21], v[44:45]
  v_pk_add_f32 v[22:23], v[22:23], v[46:47]
  v_mul_f32 v16, v16, v157
  v_mul_f32 v17, v17, v157
  v_mul_f32 v18, v18, v157
  v_mul_f32 v19, v19, v157
  v_mul_f32 v20, v20, v157
  v_mul_f32 v21, v21, v157
  v_mul_f32 v22, v22, v157
  v_mul_f32 v23, v23, v157
  v_cvt_pk_bf16_f32 v24, v16, v17
  v_cvt_pk_bf16_f32 v25, v18, v19
  v_cvt_pk_bf16_f32 v26, v20, v21
  v_cvt_pk_bf16_f32 v27, v22, v23
  s_nop 0
  v_permlane32_swap_b32 v24, v26
  v_permlane32_swap_b32 v25, v27
  v_lshlrev_b32 v16, 16, v24
  v_and_b32 v17, s64, v24
  v_lshlrev_b32 v18, 16, v25
  v_and_b32 v19, s64, v25
  v_lshlrev_b32 v20, 16, v26
  v_and_b32 v21, s64, v26
  v_lshlrev_b32 v22, 16, v27
  v_and_b32 v23, s64, v27
  v_dot2_f32_bf16 v16, v8, s60, v16
  v_dot2_f32_bf16 v17, v8, s61, v17
  v_dot2_f32_bf16 v18, v9, s60, v18
  v_dot2_f32_bf16 v19, v9, s61, v19
  v_dot2_f32_bf16 v20, v10, s60, v20
  v_dot2_f32_bf16 v21, v10, s61, v21
  v_dot2_f32_bf16 v22, v11, s60, v22
  v_dot2_f32_bf16 v23, v11, s61, v23
  v_cvt_pk_bf16_f32 v44, v16, v17
  v_cvt_pk_bf16_f32 v45, v18, v19
  v_cvt_pk_bf16_f32 v46, v20, v21
  v_cvt_pk_bf16_f32 v47, v22, v23
  v_pk_add_f32 v[24:25], v[16:17], v[18:19]
  v_pk_add_f32 v[26:27], v[20:21], v[22:23]
  v_pk_add_f32 v[24:25], v[24:25], v[26:27]
  v_add_f32 v40, v24, v25
  v_mul_f32 v26, 0xbe000000, v40
  v_pk_add_f32 v[16:17], v[16:17], v[26:27] op_sel_hi:[1,0]
  v_pk_add_f32 v[18:19], v[18:19], v[26:27] op_sel_hi:[1,0]
  v_pk_add_f32 v[20:21], v[20:21], v[26:27] op_sel_hi:[1,0]
  v_pk_add_f32 v[22:23], v[22:23], v[26:27] op_sel_hi:[1,0]
  v_pk_mul_f32 v[28:29], v[16:17], v[16:17]
  v_pk_fma_f32 v[28:29], v[18:19], v[18:19], v[28:29]
  v_pk_fma_f32 v[28:29], v[20:21], v[20:21], v[28:29]
  v_pk_fma_f32 v[28:29], v[22:23], v[22:23], v[28:29]
  v_add_f32 v41, v28, v29
  v_lshrrev_b32 v42, 1, v154
  s_add_u32 s73, s78, 6291456
  buffer_store_dwordx4 v[44:47], v154, s[40:43], s73 offen sc1
  s_lshr_b32 s73, s78, 1
  s_add_u32 s73, s73, 9437184
  buffer_store_dwordx2 v[40:41], v42, s[40:43], s73 offen sc1
  s_add_u32 s70, s77, 16891904
  buffer_load_dwordx4 v[112:115], v2, s[40:43], s70 offen offset:0 sc1
  s_add_u32 s70, s77, 16891904
  buffer_load_dwordx4 v[116:119], v2, s[40:43], s70 offen offset:1024 sc1
  s_add_u32 s70, s77, 16891904
  buffer_load_dwordx4 v[120:123], v2, s[40:43], s70 offen offset:2048 sc1
  s_add_u32 s70, s77, 16891904
  buffer_load_dwordx4 v[80:83], v2, s[40:43], s70 offen offset:3072 sc1
  s_add_u32 s70, s77, 16896000
  buffer_load_dwordx4 v[84:87], v2, s[40:43], s70 offen offset:0 sc1
  s_add_u32 s70, s77, 16896000
  buffer_load_dwordx4 v[88:91], v2, s[40:43], s70 offen offset:1024 sc1
  s_add_u32 s70, s77, 16896000
  buffer_load_dwordx4 v[92:95], v2, s[40:43], s70 offen offset:2048 sc1
  s_add_u32 s70, s77, 16896000
  buffer_load_dwordx4 v[140:143], v2, s[40:43], s70 offen offset:3072 sc1
  s_add_u32 s70, s77, 16900096
  buffer_load_dwordx4 v[96:99], v2, s[40:43], s70 offen offset:0 sc1
  s_add_u32 s70, s77, 16900096
  buffer_load_dwordx4 v[100:103], v2, s[40:43], s70 offen offset:1024 sc1
  s_add_u32 s70, s77, 16900096
  buffer_load_dwordx4 v[104:107], v2, s[40:43], s70 offen offset:2048 sc1
  s_add_u32 s70, s77, 16900096
  buffer_load_dwordx4 v[108:111], v2, s[40:43], s70 offen offset:3072 sc1
  s_waitcnt vmcnt(11)
  v_mfma_f32_32x32x16_bf16 v[48:63], a[224:227], v[112:115], 0
  s_add_u32 s81, s76, 16384
  s_mov_b64 exec, 1
  buffer_store_dwordx2 v[4:5], v0, s[40:43], s81 offen sc1
  s_mov_b64 exec, -1
  v_mfma_f32_32x32x16_bf16 v[64:79], a[228:231], v[112:115], 0
  s_add_u32 s70, s77, 16904192
  buffer_load_dwordx4 v[112:115], v2, s[40:43], s70 offen offset:0 sc1
  s_waitcnt vmcnt(12)
  v_mfma_f32_32x32x16_bf16 v[48:63], a[232:235], v[116:119], v[48:63]
  v_mfma_f32_32x32x16_bf16 v[64:79], a[236:239], v[116:119], v[64:79]
  s_add_u32 s70, s77, 16904192
  buffer_load_dwordx4 v[116:119], v2, s[40:43], s70 offen offset:1024 sc1
  s_waitcnt vmcnt(12)
  v_mfma_f32_32x32x16_bf16 v[48:63], a[240:243], v[120:123], v[48:63]
  v_mfma_f32_32x32x16_bf16 v[64:79], a[244:247], v[120:123], v[64:79]
  s_add_u32 s70, s77, 16904192
  buffer_load_dwordx4 v[120:123], v2, s[40:43], s70 offen offset:2048 sc1
  s_waitcnt vmcnt(12)
  v_mfma_f32_32x32x16_bf16 v[48:63], a[248:251], v[80:83], v[48:63]
  v_mfma_f32_32x32x16_bf16 v[64:79], a[252:255], v[80:83], v[64:79]
  s_add_u32 s70, s77, 16904192
  buffer_load_dwordx4 v[80:83], v2, s[40:43], s70 offen offset:3072 sc1
  s_waitcnt vmcnt(12)
  v_mfma_f32_32x32x16_bf16 v[48:63], v[160:163], v[84:87], v[48:63]
  v_mfma_f32_32x32x16_bf16 v[64:79], v[164:167], v[84:87], v[64:79]
  s_add_u32 s70, s77, 16908288
  buffer_load_dwordx4 v[84:87], v2, s[40:43], s70 offen offset:0 sc1
  s_waitcnt vmcnt(12)
  v_mfma_f32_32x32x16_bf16 v[48:63], v[168:171], v[88:91], v[48:63]
  v_mfma_f32_32x32x16_bf16 v[64:79], v[172:175], v[88:91], v[64:79]
  s_add_u32 s70, s77, 16908288
  buffer_load_dwordx4 v[88:91], v2, s[40:43], s70 offen offset:1024 sc1
  s_waitcnt vmcnt(12)
  v_mfma_f32_32x32x16_bf16 v[48:63], v[176:179], v[92:95], v[48:63]
  v_mfma_f32_32x32x16_bf16 v[64:79], v[180:183], v[92:95], v[64:79]
  s_add_u32 s70, s77, 16908288
  buffer_load_dwordx4 v[92:95], v2, s[40:43], s70 offen offset:2048 sc1
  s_waitcnt vmcnt(12)
  v_mfma_f32_32x32x16_bf16 v[48:63], v[184:187], v[140:143], v[48:63]
  v_mfma_f32_32x32x16_bf16 v[64:79], v[188:191], v[140:143], v[64:79]
  s_add_u32 s70, s77, 16908288
  buffer_load_dwordx4 v[140:143], v2, s[40:43], s70 offen offset:3072 sc1
  s_waitcnt vmcnt(12)
  v_mfma_f32_32x32x16_bf16 v[48:63], v[192:195], v[96:99], v[48:63]
  v_mfma_f32_32x32x16_bf16 v[64:79], v[196:199], v[96:99], v[64:79]
  s_add_u32 s70, s77, 16912384
  buffer_load_dwordx4 v[96:99], v2, s[40:43], s70 offen offset:0 sc1
  s_waitcnt vmcnt(12)
  v_mfma_f32_32x32x16_bf16 v[48:63], v[200:203], v[100:103], v[48:63]
  v_mfma_f32_32x32x16_bf16 v[64:79], v[204:207], v[100:103], v[64:79]
  s_add_u32 s70, s77, 16912384
  buffer_load_dwordx4 v[100:103], v2, s[40:43], s70 offen offset:1024 sc1
  s_waitcnt vmcnt(12)
  v_mfma_f32_32x32x16_bf16 v[48:63], v[208:211], v[104:107], v[48:63]
  v_mfma_f32_32x32x16_bf16 v[64:79], v[212:215], v[104:107], v[64:79]
  s_add_u32 s70, s77, 16912384
  buffer_load_dwordx4 v[104:107], v2, s[40:43], s70 offen offset:2048 sc1
  s_waitcnt vmcnt(12)
  v_mfma_f32_32x32x16_bf16 v[48:63], v[216:219], v[108:111], v[48:63]
  v_mfma_f32_32x32x16_bf16 v[64:79], v[220:223], v[108:111], v[64:79]
  s_add_u32 s70, s77, 16912384
  buffer_load_dwordx4 v[108:111], v2, s[40:43], s70 offen offset:3072 sc1
  s_waitcnt vmcnt(11)
  v_mfma_f32_32x32x16_bf16 v[48:63], v[224:227], v[112:115], v[48:63]
  v_mfma_f32_32x32x16_bf16 v[64:79], v[228:231], v[112:115], v[64:79]
  s_add_u32 s70, s77, 16916480
  buffer_load_dwordx4 v[112:115], v2, s[40:43], s70 offen offset:0 sc1
  s_waitcnt vmcnt(11)
  v_mfma_f32_32x32x16_bf16 v[48:63], v[232:235], v[116:119], v[48:63]
  v_mfma_f32_32x32x16_bf16 v[64:79], v[236:239], v[116:119], v[64:79]
  s_add_u32 s70, s77, 16916480
  buffer_load_dwordx4 v[116:119], v2, s[40:43], s70 offen offset:1024 sc1
  ds_read_b128 v[124:127], v152 offset:0
  ds_read_b128 v[128:131], v152 offset:1024
  s_waitcnt vmcnt(11)
  v_mfma_f32_32x32x16_bf16 v[48:63], v[240:243], v[120:123], v[48:63]
  v_mfma_f32_32x32x16_bf16 v[64:79], v[244:247], v[120:123], v[64:79]
  s_add_u32 s70, s77, 16916480
  buffer_load_dwordx4 v[120:123], v2, s[40:43], s70 offen offset:2048 sc1
  ds_read_b128 v[132:135], v152 offset:8192
  ds_read_b128 v[136:139], v152 offset:9216
  s_waitcnt vmcnt(11)
  v_mfma_f32_32x32x16_bf16 v[48:63], v[248:251], v[80:83], v[48:63]
  v_mfma_f32_32x32x16_bf16 v[64:79], v[252:255], v[80:83], v[64:79]
  s_add_u32 s70, s77, 16916480
  buffer_load_dwordx4 v[80:83], v2, s[40:43], s70 offen offset:3072 sc1
  s_waitcnt vmcnt(11) lgkmcnt(2)
  v_mfma_f32_32x32x16_bf16 v[48:63], v[124:127], v[84:87], v[48:63]
  v_mfma_f32_32x32x16_bf16 v[64:79], v[128:131], v[84:87], v[64:79]
  ds_read_b128 v[124:127], v152 offset:16384
  ds_read_b128 v[128:131], v152 offset:17408
  s_waitcnt vmcnt(10) lgkmcnt(2)
  v_mfma_f32_32x32x16_bf16 v[48:63], v[132:135], v[88:91], v[48:63]
  v_mfma_f32_32x32x16_bf16 v[64:79], v[136:139], v[88:91], v[64:79]
  ds_read_b128 v[132:135], v152 offset:24576
  ds_read_b128 v[136:139], v152 offset:25600
  s_waitcnt vmcnt(9) lgkmcnt(2)
  v_mfma_f32_32x32x16_bf16 v[48:63], v[124:127], v[92:95], v[48:63]
  s_add_u32 s82, s69, 16384
  buffer_load_dwordx2 v[44:45], v145, s[40:43], s82 offen sc1
  v_mfma_f32_32x32x16_bf16 v[64:79], v[128:131], v[92:95], v[64:79]
  ds_read_b128 v[124:127], v152 offset:32768
  ds_read_b128 v[128:131], v152 offset:33792
  s_waitcnt vmcnt(9) lgkmcnt(2)
  v_mfma_f32_32x32x16_bf16 v[48:63], v[132:135], v[140:143], v[48:63]
  v_mfma_f32_32x32x16_bf16 v[64:79], v[136:139], v[140:143], v[64:79]
  ds_read_b128 v[132:135], v152 offset:40960
  ds_read_b128 v[136:139], v152 offset:41984
  s_waitcnt vmcnt(8) lgkmcnt(2)
  v_mfma_f32_32x32x16_bf16 v[48:63], v[124:127], v[96:99], v[48:63]
  v_mfma_f32_32x32x16_bf16 v[64:79], v[128:131], v[96:99], v[64:79]
  ds_read_b128 v[124:127], v152 offset:49152
  ds_read_b128 v[128:131], v152 offset:50176
  s_waitcnt vmcnt(7) lgkmcnt(2)
  v_mfma_f32_32x32x16_bf16 v[48:63], v[132:135], v[100:103], v[48:63]
  v_mfma_f32_32x32x16_bf16 v[64:79], v[136:139], v[100:103], v[64:79]
  ds_read_b128 v[132:135], v152 offset:57344
  ds_read_b128 v[136:139], v152 offset:58368
  s_waitcnt vmcnt(6) lgkmcnt(2)
  v_mfma_f32_32x32x16_bf16 v[48:63], v[124:127], v[104:107], v[48:63]
  v_mfma_f32_32x32x16_bf16 v[64:79], v[128:131], v[104:107], v[64:79]
  v_add_u32 v152, 0x10000, v152
  ds_read_b128 v[124:127], v152 offset:0
  ds_read_b128 v[128:131], v152 offset:1024
  s_waitcnt vmcnt(5) lgkmcnt(2)
  v_mfma_f32_32x32x16_bf16 v[48:63], v[132:135], v[108:111], v[48:63]
  v_mfma_f32_32x32x16_bf16 v[64:79], v[136:139], v[108:111], v[64:79]
  ds_read_b128 v[132:135], v152 offset:8192
  ds_read_b128 v[136:139], v152 offset:9216
  s_waitcnt vmcnt(4) lgkmcnt(2)
  v_mfma_f32_32x32x16_bf16 v[48:63], v[124:127], v[112:115], v[48:63]
  v_mfma_f32_32x32x16_bf16 v[64:79], v[128:131], v[112:115], v[64:79]
  ds_read_b128 v[124:127], v152 offset:16384
  ds_read_b128 v[128:131], v152 offset:17408
  s_waitcnt vmcnt(3) lgkmcnt(2)
  v_mfma_f32_32x32x16_bf16 v[48:63], v[132:135], v[116:119], v[48:63]
  v_mfma_f32_32x32x16_bf16 v[64:79], v[136:139], v[116:119], v[64:79]
  ds_read_b128 v[132:135], v152 offset:24576
  ds_read_b128 v[136:139], v152 offset:25600
  s_waitcnt vmcnt(2) lgkmcnt(2)
  v_mfma_f32_32x32x16_bf16 v[48:63], v[124:127], v[120:123], v[48:63]
  s_waitcnt vmcnt(0)
PX0:
  v_xor_b32 v44, s66, v44
  v_xor_b32 v45, s67, v45
  v_or_b32 v44, v44, v45
  v_cmp_ne_u32 vcc, 0, v44
  s_nop 0
  s_cbranch_vccz PX0_D
  s_add_u32 s83, s83, 1
  s_cmp_gt_u32 s83, 0x40000
  s_cbranch_scc1 PX0_D
  s_sleep 4
  buffer_load_dwordx2 v[44:45], v145, s[40:43], s82 offen sc1
  s_waitcnt vmcnt(0)
  s_branch PX0
PX0_D:
  s_add_u32 s72, s71, 6291456
  s_add_u32 s74, s71, 6295552
  buffer_load_dwordx4 v[16:19], v2, s[40:43], s72 offen offset:0 sc1
  buffer_load_dwordx4 v[20:23], v2, s[40:43], s72 offen offset:1024 sc1
  v_mfma_f32_32x32x16_bf16 v[64:79], v[128:131], v[120:123], v[64:79]
  buffer_load_dwordx4 v[24:27], v2, s[40:43], s72 offen offset:2048 sc1
  buffer_load_dwordx4 v[28:31], v2, s[40:43], s72 offen offset:3072 sc1
  buffer_load_dwordx4 v[32:35], v2, s[40:43], s74 offen offset:0 sc1
  buffer_load_dwordx4 v[36:39], v2, s[40:43], s74 offen offset:1024 sc1
  buffer_load_dwordx4 v[40:43], v2, s[40:43], s74 offen offset:2048 sc1
  s_waitcnt lgkmcnt(0)
  v_mfma_f32_32x32x16_bf16 v[48:63], v[132:135], v[80:83], v[48:63]
  v_mfma_f32_32x32x16_bf16 v[64:79], v[136:139], v[80:83], v[64:79]
  v_subrev_u32 v152, 0x10000, v152
  s_cmp_lg_u32 s3, 0
  s_cbranch_scc1 E2_01_R1
  s_nop 7
  ds_write_b128 v148, v[56:59] offset:38976
  ds_write_b128 v148, v[60:63] offset:40000
  ds_write_b128 v148, v[64:67] offset:43072
  ds_write_b128 v148, v[68:71] offset:44096
  ds_write_b128 v148, v[72:75] offset:47168
  ds_write_b128 v148, v[76:79] offset:48192
  s_branch E2_01_RD
E2_01_R1:
  s_cmp_lg_u32 s3, 1
  s_cbranch_scc1 E2_01_R2
  s_nop 5
  ds_write_b128 v148, v[48:51] offset:28736
  ds_write_b128 v148, v[52:55] offset:29760
  ds_write_b128 v148, v[64:67] offset:45120
  ds_write_b128 v148, v[68:71] offset:46144
  ds_write_b128 v148, v[72:75] offset:49216
  ds_write_b128 v148, v[76:79] offset:50240
  v_mov_b32 v48, v56
  v_mov_b32 v49, v57
  v_mov_b32 v50, v58
  v_mov_b32 v51, v59
  v_mov_b32 v52, v60
  v_mov_b32 v53, v61
  v_mov_b32 v54, v62
  v_mov_b32 v55, v63
  s_branch E2_01_RD
E2_01_R2:
  s_cmp_lg_u32 s3, 2
  s_cbranch_scc1 E2_01_R3
  s_nop 3
  ds_write_b128 v148, v[48:51] offset:30784
  ds_write_b128 v148, v[52:55] offset:31808
  ds_write_b128 v148, v[56:59] offset:34880
  ds_write_b128 v148, v[60:63] offset:35904
  ds_write_b128 v148, v[72:75] offset:51264
  ds_write_b128 v148, v[76:79] offset:52288
  v_mov_b32 v48, v64
  v_mov_b32 v49, v65
  v_mov_b32 v50, v66
  v_mov_b32 v51, v67
  v_mov_b32 v52, v68
  v_mov_b32 v53, v69
  v_mov_b32 v54, v70
  v_mov_b32 v55, v71
  s_branch E2_01_RD
E2_01_R3:
  s_nop 3
  ds_write_b128 v148, v[48:51] offset:32832
  ds_write_b128 v148, v[52:55] offset:33856
  ds_write_b128 v148, v[56:59] offset:36928
  ds_write_b128 v148, v[60:63] offset:37952
  ds_write_b128 v148, v[64:67] offset:41024
  ds_write_b128 v148, v[68:71] offset:42048
  v_mov_b32 v48, v72
  v_mov_b32 v49, v73
  v_mov_b32 v50, v74
  v_mov_b32 v51, v75
  v_mov_b32 v52, v76
  v_mov_b32 v53, v77
  v_mov_b32 v54, v78
  v_mov_b32 v55, v79
E2_01_RD:
  s_lshr_b32 s72, s71, 1
  s_add_u32 s72, s72, 9437184
  buffer_load_dwordx2 v[108:109], v144, s[40:43], s72 offen offset:0 sc1
  buffer_load_dwordx2 v[110:111], v144, s[40:43], s72 offen offset:512 sc1
  buffer_load_dwordx2 v[112:113], v144, s[40:43], s72 offen offset:1024 sc1
  buffer_load_dwordx2 v[114:115], v144, s[40:43], s72 offen offset:1536 sc1
  buffer_load_dwordx2 v[116:117], v144, s[40:43], s72 offen offset:2048 sc1
  buffer_load_dwordx2 v[118:119], v144, s[40:43], s72 offen offset:2560 sc1
  buffer_load_dwordx2 v[120:121], v144, s[40:43], s72 offen offset:3072 sc1
  s_add_u32 s72, s71, 4194304
  s_add_u32 s74, s71, 4198400
  buffer_load_dwordx4 v[80:83], v2, s[40:43], s72 offen offset:0 sc1
  buffer_load_dwordx4 v[84:87], v2, s[40:43], s72 offen offset:1024 sc1
  buffer_load_dwordx4 v[88:91], v2, s[40:43], s72 offen offset:2048 sc1
  buffer_load_dwordx4 v[92:95], v2, s[40:43], s72 offen offset:3072 sc1
  buffer_load_dwordx4 v[96:99], v2, s[40:43], s74 offen offset:0 sc1
  buffer_load_dwordx4 v[100:103], v2, s[40:43], s74 offen offset:1024 sc1
  buffer_load_dwordx4 v[104:107], v2, s[40:43], s74 offen offset:2048 sc1
  s_waitcnt lgkmcnt(0)
  s_barrier
  ds_read_b128 v[56:59], v153 offset:28736
  ds_read_b128 v[60:63], v153 offset:29760
  ds_read_b128 v[64:67], v153 offset:30784
  ds_read_b128 v[68:71], v153 offset:31808
  ds_read_b128 v[72:75], v153 offset:32832
  ds_read_b128 v[76:79], v153 offset:33856
  s_waitcnt lgkmcnt(4)
  v_pk_add_f32 v[48:49], v[48:49], v[56:57]
  v_pk_add_f32 v[50:51], v[50:51], v[58:59]
  v_pk_add_f32 v[52:53], v[52:53], v[60:61]
  v_pk_add_f32 v[54:55], v[54:55], v[62:63]
  s_waitcnt lgkmcnt(2)
  v_pk_add_f32 v[48:49], v[48:49], v[64:65]
  v_pk_add_f32 v[50:51], v[50:51], v[66:67]
  v_pk_add_f32 v[52:53], v[52:53], v[68:69]
  v_pk_add_f32 v[54:55], v[54:55], v[70:71]
  s_waitcnt lgkmcnt(0)
  v_pk_add_f32 v[48:49], v[48:49], v[72:73]
  v_pk_add_f32 v[50:51], v[50:51], v[74:75]
  v_pk_add_f32 v[52:53], v[52:53], v[76:77]
  v_pk_add_f32 v[54:55], v[54:55], v[78:79]
  v_mul_f32 v48, v48, v159
  v_mul_f32 v49, v49, v159
  v_mul_f32 v50, v50, v159
  v_mul_f32 v51, v51, v159
  v_mul_f32 v52, v52, v159
  v_mul_f32 v53, v53, v159
  v_mul_f32 v54, v54, v159
  v_mul_f32 v55, v55, v159
  v_cvt_pk_bf16_f32 v56, v48, v49
  v_cvt_pk_bf16_f32 v57, v50, v51
  v_cvt_pk_bf16_f32 v58, v52, v53
  v_cvt_pk_bf16_f32 v59, v54, v55
  s_nop 0
  v_permlane32_swap_b32 v56, v58
  v_permlane32_swap_b32 v57, v59
  v_lshlrev_b32 v48, 16, v56
  v_and_b32 v49, s64, v56
  v_lshlrev_b32 v50, 16, v57
  v_and_b32 v51, s64, v57
  v_lshlrev_b32 v52, 16, v58
  v_and_b32 v53, s64, v58
  v_lshlrev_b32 v54, 16, v59
  v_and_b32 v55, s64, v59
  v_dot2_f32_bf16 v48, v12, s60, v48
  v_dot2_f32_bf16 v49, v12, s61, v49
  v_dot2_f32_bf16 v50, v13, s60, v50
  v_dot2_f32_bf16 v51, v13, s61, v51
  v_dot2_f32_bf16 v52, v14, s60, v52
  v_dot2_f32_bf16 v53, v14, s61, v53
  v_dot2_f32_bf16 v54, v15, s60, v54
  v_dot2_f32_bf16 v55, v15, s61, v55
  v_cvt_pk_bf16_f32 v76, v48, v49
  v_cvt_pk_bf16_f32 v77, v50, v51
  v_cvt_pk_bf16_f32 v78, v52, v53
  v_cvt_pk_bf16_f32 v79, v54, v55
  v_pk_add_f32 v[56:57], v[48:49], v[50:51]
  v_pk_add_f32 v[58:59], v[52:53], v[54:55]
  v_pk_add_f32 v[56:57], v[56:57], v[58:59]
  v_add_f32 v72, v56, v57
  v_mul_f32 v58, 0xbe000000, v72
  v_pk_add_f32 v[48:49], v[48:49], v[58:59] op_sel_hi:[1,0]
  v_pk_add_f32 v[50:51], v[50:51], v[58:59] op_sel_hi:[1,0]
  v_pk_add_f32 v[52:53], v[52:53], v[58:59] op_sel_hi:[1,0]
  v_pk_add_f32 v[54:55], v[54:55], v[58:59] op_sel_hi:[1,0]
  v_pk_mul_f32 v[60:61], v[48:49], v[48:49]
  v_pk_fma_f32 v[60:61], v[50:51], v[50:51], v[60:61]
  v_pk_fma_f32 v[60:61], v[52:53], v[52:53], v[60:61]
  v_pk_fma_f32 v[60:61], v[54:55], v[54:55], v[60:61]
  v_add_f32 v73, v60, v61
  v_lshrrev_b32 v74, 1, v154
  s_add_u32 s73, s78, 6320128
  buffer_store_dwordx4 v[76:79], v154, s[40:43], s73 offen sc1
  s_lshr_b32 s73, s78, 1
  s_add_u32 s73, s73, 9451520
  buffer_store_dwordx2 v[72:73], v74, s[40:43], s73 offen sc1
  s_waitcnt vmcnt(9)
  v_add_f32 v122, v108, v110
  v_add_f32 v125, v109, v111
  v_add_f32 v122, v122, v112
  v_add_f32 v125, v125, v113
  v_add_f32 v122, v122, v114
  v_add_f32 v125, v125, v115
  v_add_f32 v122, v122, v116
  v_add_f32 v125, v125, v117
  v_add_f32 v122, v122, v118
  v_add_f32 v125, v125, v119
  v_add_f32 v122, v122, v120
  v_add_f32 v125, v125, v121
  s_nop 0
  v_add_f32 v122, v122, v122 row_ror:8
  v_mov_b32 v123, v122
  s_nop 1
  v_permlane16_swap_b32 v122, v123
  v_add_f32 v122, v122, v123
  v_mov_b32 v123, v122
  s_nop 1
  v_permlane32_swap_b32 v122, v123
  v_add_f32 v122, v122, v123
  v_mul_f32 v122, s63, v122
  v_mul_f32 v123, 0xc1000000, v122
  v_add_f32 v108, v108, v123
  v_add_f32 v110, v110, v123
  v_add_f32 v112, v112, v123
  v_add_f32 v114, v114, v123
  v_add_f32 v116, v116, v123
  v_add_f32 v118, v118, v123
  v_add_f32 v120, v120, v123
  v_mul_f32 v124, v108, v108
  v_fmac_f32 v124, v110, v110
  v_fmac_f32 v124, v112, v112
  v_fmac_f32 v124, v114, v114
  v_fmac_f32 v124, v116, v116
  v_fmac_f32 v124, v118, v118
  v_fmac_f32 v124, v120, v120
  v_fmac_f32 v125, 0x3e000000, v124
  v_cvt_pk_bf16_f32 v8, v122, v122
  v_lshlrev_b32 v8, 16, v8
  v_add_f32 v125, v125, v125 row_ror:8
  v_mov_b32 v123, v125
  s_nop 1
  v_permlane16_swap_b32 v125, v123
  v_add_f32 v125, v125, v123
  v_mov_b32 v123, v125
  s_nop 1
  v_permlane32_swap_b32 v125, v123
  v_add_f32 v125, v125, v123
  v_mul_f32 v125, s63, v125
  v_max_f32 v125, 0, v125
  v_cvt_pk_bf16_f32 v125, v125, v125
  v_lshlrev_b32 v125, 16, v125
  v_add_f32 v125, 0x3727c5ac, v125
  v_cvt_pk_bf16_f32 v125, v125, v125
  v_lshlrev_b32 v125, 16, v125
  v_sqrt_f32 v125, v125
  s_nop 0
  v_cvt_pk_bf16_f32 v125, v125, v125
  v_lshlrev_b32 v125, 16, v125
  v_rcp_f32 v10, v125
  s_nop 0
  v_mul_f32 v11, v8, v10
  v_sub_f32 v11, 0, v11
  s_waitcnt vmcnt(2)
  v_lshlrev_b32 v108, 16, v16
  v_and_b32 v109, s64, v16
  v_lshlrev_b32 v110, 16, v17
  v_and_b32 v111, s64, v17
  v_lshlrev_b32 v112, 16, v18
  v_and_b32 v113, s64, v18
  v_lshlrev_b32 v114, 16, v19
  v_and_b32 v115, s64, v19
  v_pk_fma_f32 v[116:117], v[108:109], v[10:11], v[10:11] op_sel:[0,0,1] op_sel_hi:[1,0,1]
  v_pk_fma_f32 v[118:119], v[110:111], v[10:11], v[10:11] op_sel:[0,0,1] op_sel_hi:[1,0,1]
  v_lshlrev_b32 v120, 16, v80
  v_and_b32 v121, s64, v80
  v_lshlrev_b32 v122, 16, v81
  v_and_b32 v123, s64, v81
  v_pk_fma_f32 v[108:109], v[116:117], v[120:121], v[108:109]
  v_pk_fma_f32 v[110:111], v[118:119], v[122:123], v[110:111]
  v_pk_fma_f32 v[116:117], v[112:113], v[10:11], v[10:11] op_sel:[0,0,1] op_sel_hi:[1,0,1]
  v_pk_fma_f32 v[118:119], v[114:115], v[10:11], v[10:11] op_sel:[0,0,1] op_sel_hi:[1,0,1]
  v_lshlrev_b32 v120, 16, v82
  v_and_b32 v121, s64, v82
  v_lshlrev_b32 v122, 16, v83
  v_and_b32 v123, s64, v83
  v_pk_fma_f32 v[112:113], v[116:117], v[120:121], v[112:113]
  v_pk_fma_f32 v[114:115], v[118:119], v[122:123], v[114:115]
  v_cvt_pk_bf16_f32 v16, v108, v109
  v_cvt_pk_bf16_f32 v17, v110, v111
  v_cvt_pk_bf16_f32 v18, v112, v113
  v_cvt_pk_bf16_f32 v19, v114, v115
  ds_write_b128 v146, v[16:19] offset:0
  v_dot2_f32_bf16 v124, v16, s62, 0
  v_dot2_f32_bf16 v125, v16, v16, 0
  v_dot2_f32_bf16 v124, v17, s62, v124
  v_dot2_f32_bf16 v125, v17, v17, v125
  v_dot2_f32_bf16 v124, v18, s62, v124
  v_dot2_f32_bf16 v125, v18, v18, v125
  v_dot2_f32_bf16 v124, v19, s62, v124
  v_dot2_f32_bf16 v125, v19, v19, v125
  v_lshlrev_b32 v108, 16, v20
  v_and_b32 v109, s64, v20
  v_lshlrev_b32 v110, 16, v21
  v_and_b32 v111, s64, v21
  v_lshlrev_b32 v112, 16, v22
  v_and_b32 v113, s64, v22
  v_lshlrev_b32 v114, 16, v23
  v_and_b32 v115, s64, v23
  v_pk_fma_f32 v[116:117], v[108:109], v[10:11], v[10:11] op_sel:[0,0,1] op_sel_hi:[1,0,1]
  v_pk_fma_f32 v[118:119], v[110:111], v[10:11], v[10:11] op_sel:[0,0,1] op_sel_hi:[1,0,1]
  v_lshlrev_b32 v120, 16, v84
  v_and_b32 v121, s64, v84
  v_lshlrev_b32 v122, 16, v85
  v_and_b32 v123, s64, v85
  v_pk_fma_f32 v[108:109], v[116:117], v[120:121], v[108:109]
  v_pk_fma_f32 v[110:111], v[118:119], v[122:123], v[110:111]
  v_pk_fma_f32 v[116:117], v[112:113], v[10:11], v[10:11] op_sel:[0,0,1] op_sel_hi:[1,0,1]
  v_pk_fma_f32 v[118:119], v[114:115], v[10:11], v[10:11] op_sel:[0,0,1] op_sel_hi:[1,0,1]
  v_lshlrev_b32 v120, 16, v86
  v_and_b32 v121, s64, v86
  v_lshlrev_b32 v122, 16, v87
  v_and_b32 v123, s64, v87
  v_pk_fma_f32 v[112:113], v[116:117], v[120:121], v[112:113]
  v_pk_fma_f32 v[114:115], v[118:119], v[122:123], v[114:115]
  v_cvt_pk_bf16_f32 v20, v108, v109
  v_cvt_pk_bf16_f32 v21, v110, v111
  v_cvt_pk_bf16_f32 v22, v112, v113
  v_cvt_pk_bf16_f32 v23, v114, v115
  ds_write_b128 v146, v[20:23] offset:4096
  v_dot2_f32_bf16 v124, v20, s62, v124
  v_dot2_f32_bf16 v125, v20, v20, v125
  v_dot2_f32_bf16 v124, v21, s62, v124
  v_dot2_f32_bf16 v125, v21, v21, v125
  v_dot2_f32_bf16 v124, v22, s62, v124
  v_dot2_f32_bf16 v125, v22, v22, v125
  v_dot2_f32_bf16 v124, v23, s62, v124
  v_dot2_f32_bf16 v125, v23, v23, v125
  v_lshlrev_b32 v108, 16, v24
  v_and_b32 v109, s64, v24
  v_lshlrev_b32 v110, 16, v25
  v_and_b32 v111, s64, v25
  v_lshlrev_b32 v112, 16, v26
  v_and_b32 v113, s64, v26
  v_lshlrev_b32 v114, 16, v27
  v_and_b32 v115, s64, v27
  v_pk_fma_f32 v[116:117], v[108:109], v[10:11], v[10:11] op_sel:[0,0,1] op_sel_hi:[1,0,1]
  v_pk_fma_f32 v[118:119], v[110:111], v[10:11], v[10:11] op_sel:[0,0,1] op_sel_hi:[1,0,1]
  v_lshlrev_b32 v120, 16, v88
  v_and_b32 v121, s64, v88
  v_lshlrev_b32 v122, 16, v89
  v_and_b32 v123, s64, v89
  v_pk_fma_f32 v[108:109], v[116:117], v[120:121], v[108:109]
  v_pk_fma_f32 v[110:111], v[118:119], v[122:123], v[110:111]
  v_pk_fma_f32 v[116:117], v[112:113], v[10:11], v[10:11] op_sel:[0,0,1] op_sel_hi:[1,0,1]
  v_pk_fma_f32 v[118:119], v[114:115], v[10:11], v[10:11] op_sel:[0,0,1] op_sel_hi:[1,0,1]
  v_lshlrev_b32 v120, 16, v90
  v_and_b32 v121, s64, v90
  v_lshlrev_b32 v122, 16, v91
  v_and_b32 v123, s64, v91
  v_pk_fma_f32 v[112:113], v[116:117], v[120:121], v[112:113]
  v_pk_fma_f32 v[114:115], v[118:119], v[122:123], v[114:115]
  v_cvt_pk_bf16_f32 v24, v108, v109
  v_cvt_pk_bf16_f32 v25, v110, v111
  v_cvt_pk_bf16_f32 v26, v112, v113
  v_cvt_pk_bf16_f32 v27, v114, v115
  ds_write_b128 v146, v[24:27] offset:8192
  v_dot2_f32_bf16 v124, v24, s62, v124
  v_dot2_f32_bf16 v125, v24, v24, v125
  v_dot2_f32_bf16 v124, v25, s62, v124
  v_dot2_f32_bf16 v125, v25, v25, v125
  v_dot2_f32_bf16 v124, v26, s62, v124
  v_dot2_f32_bf16 v125, v26, v26, v125
  v_dot2_f32_bf16 v124, v27, s62, v124
  v_dot2_f32_bf16 v125, v27, v27, v125
  v_lshlrev_b32 v108, 16, v28
  v_and_b32 v109, s64, v28
  v_lshlrev_b32 v110, 16, v29
  v_and_b32 v111, s64, v29
  v_lshlrev_b32 v112, 16, v30
  v_and_b32 v113, s64, v30
  v_lshlrev_b32 v114, 16, v31
  v_and_b32 v115, s64, v31
  v_pk_fma_f32 v[116:117], v[108:109], v[10:11], v[10:11] op_sel:[0,0,1] op_sel_hi:[1,0,1]
  v_pk_fma_f32 v[118:119], v[110:111], v[10:11], v[10:11] op_sel:[0,0,1] op_sel_hi:[1,0,1]
  v_lshlrev_b32 v120, 16, v92
  v_and_b32 v121, s64, v92
  v_lshlrev_b32 v122, 16, v93
  v_and_b32 v123, s64, v93
  v_pk_fma_f32 v[108:109], v[116:117], v[120:121], v[108:109]
  s_waitcnt vmcnt(0)
  s_add_u32 s81, s76, 24576
  s_mov_b64 exec, 1
  buffer_store_dwordx2 v[4:5], v0, s[40:43], s81 offen sc1
  s_mov_b64 exec, -1
  v_pk_fma_f32 v[110:111], v[118:119], v[122:123], v[110:111]
  v_pk_fma_f32 v[116:117], v[112:113], v[10:11], v[10:11] op_sel:[0,0,1] op_sel_hi:[1,0,1]
  v_pk_fma_f32 v[118:119], v[114:115], v[10:11], v[10:11] op_sel:[0,0,1] op_sel_hi:[1,0,1]
  v_lshlrev_b32 v120, 16, v94
  v_and_b32 v121, s64, v94
  v_lshlrev_b32 v122, 16, v95
  v_and_b32 v123, s64, v95
  v_pk_fma_f32 v[112:113], v[116:117], v[120:121], v[112:113]
  v_pk_fma_f32 v[114:115], v[118:119], v[122:123], v[114:115]
  v_cvt_pk_bf16_f32 v28, v108, v109
  v_cvt_pk_bf16_f32 v29, v110, v111
  v_cvt_pk_bf16_f32 v30, v112, v113
  v_cvt_pk_bf16_f32 v31, v114, v115
  ds_write_b128 v146, v[28:31] offset:12288
  v_dot2_f32_bf16 v124, v28, s62, v124
  v_dot2_f32_bf16 v125, v28, v28, v125
  v_dot2_f32_bf16 v124, v29, s62, v124
  v_dot2_f32_bf16 v125, v29, v29, v125
  v_dot2_f32_bf16 v124, v30, s62, v124
  v_dot2_f32_bf16 v125, v30, v30, v125
  v_dot2_f32_bf16 v124, v31, s62, v124
  v_dot2_f32_bf16 v125, v31, v31, v125
  v_lshlrev_b32 v108, 16, v32
  v_and_b32 v109, s64, v32
  v_lshlrev_b32 v110, 16, v33
  v_and_b32 v111, s64, v33
  v_lshlrev_b32 v112, 16, v34
  v_and_b32 v113, s64, v34
  v_lshlrev_b32 v114, 16, v35
  v_and_b32 v115, s64, v35
  v_pk_fma_f32 v[116:117], v[108:109], v[10:11], v[10:11] op_sel:[0,0,1] op_sel_hi:[1,0,1]
  v_pk_fma_f32 v[118:119], v[110:111], v[10:11], v[10:11] op_sel:[0,0,1] op_sel_hi:[1,0,1]
  v_lshlrev_b32 v120, 16, v96
  v_and_b32 v121, s64, v96
  v_lshlrev_b32 v122, 16, v97
  v_and_b32 v123, s64, v97
  v_pk_fma_f32 v[108:109], v[116:117], v[120:121], v[108:109]
  v_pk_fma_f32 v[110:111], v[118:119], v[122:123], v[110:111]
  v_pk_fma_f32 v[116:117], v[112:113], v[10:11], v[10:11] op_sel:[0,0,1] op_sel_hi:[1,0,1]
  v_pk_fma_f32 v[118:119], v[114:115], v[10:11], v[10:11] op_sel:[0,0,1] op_sel_hi:[1,0,1]
  v_lshlrev_b32 v120, 16, v98
  v_and_b32 v121, s64, v98
  v_lshlrev_b32 v122, 16, v99
  v_and_b32 v123, s64, v99
  v_pk_fma_f32 v[112:113], v[116:117], v[120:121], v[112:113]
  v_pk_fma_f32 v[114:115], v[118:119], v[122:123], v[114:115]
  v_cvt_pk_bf16_f32 v32, v108, v109
  v_cvt_pk_bf16_f32 v33, v110, v111
  v_cvt_pk_bf16_f32 v34, v112, v113
  v_cvt_pk_bf16_f32 v35, v114, v115
  ds_write_b128 v146, v[32:35] offset:16384
  s_add_u32 s72, s71, 4222976
  buffer_load_dwordx4 v[80:83], v2, s[40:43], s72 offen sc1
  s_add_u32 s72, s71, 4224000
  buffer_load_dwordx4 v[84:87], v2, s[40:43], s72 offen sc1
  s_add_u32 s72, s71, 4225024
  buffer_load_dwordx4 v[88:91], v2, s[40:43], s72 offen sc1
  s_add_u32 s72, s71, 4226048
  buffer_load_dwordx4 v[92:95], v2, s[40:43], s72 offen sc1
  s_add_u32 s72, s71, 4227072
  buffer_load_dwordx4 v[96:99], v2, s[40:43], s72 offen sc1
  v_dot2_f32_bf16 v124, v32, s62, v124
  v_dot2_f32_bf16 v125, v32, v32, v125
  v_dot2_f32_bf16 v124, v33, s62, v124
  v_dot2_f32_bf16 v125, v33, v33, v125
  v_dot2_f32_bf16 v124, v34, s62, v124
  v_dot2_f32_bf16 v125, v34, v34, v125
  v_dot2_f32_bf16 v124, v35, s62, v124
  v_dot2_f32_bf16 v125, v35, v35, v125
  v_lshlrev_b32 v108, 16, v36
  v_and_b32 v109, s64, v36
  v_lshlrev_b32 v110, 16, v37
  v_and_b32 v111, s64, v37
  v_lshlrev_b32 v112, 16, v38
  v_and_b32 v113, s64, v38
  v_lshlrev_b32 v114, 16, v39
  v_and_b32 v115, s64, v39
  v_pk_fma_f32 v[116:117], v[108:109], v[10:11], v[10:11] op_sel:[0,0,1] op_sel_hi:[1,0,1]
  v_pk_fma_f32 v[118:119], v[110:111], v[10:11], v[10:11] op_sel:[0,0,1] op_sel_hi:[1,0,1]
  v_lshlrev_b32 v120, 16, v100
  v_and_b32 v121, s64, v100
  v_lshlrev_b32 v122, 16, v101
  v_and_b32 v123, s64, v101
  v_pk_fma_f32 v[108:109], v[116:117], v[120:121], v[108:109]
  v_pk_fma_f32 v[110:111], v[118:119], v[122:123], v[110:111]
  v_pk_fma_f32 v[116:117], v[112:113], v[10:11], v[10:11] op_sel:[0,0,1] op_sel_hi:[1,0,1]
  v_pk_fma_f32 v[118:119], v[114:115], v[10:11], v[10:11] op_sel:[0,0,1] op_sel_hi:[1,0,1]
  v_lshlrev_b32 v120, 16, v102
  v_and_b32 v121, s64, v102
  v_lshlrev_b32 v122, 16, v103
  v_and_b32 v123, s64, v103
  v_pk_fma_f32 v[112:113], v[116:117], v[120:121], v[112:113]
  v_pk_fma_f32 v[114:115], v[118:119], v[122:123], v[114:115]
  v_cvt_pk_bf16_f32 v36, v108, v109
  v_cvt_pk_bf16_f32 v37, v110, v111
  v_cvt_pk_bf16_f32 v38, v112, v113
  v_cvt_pk_bf16_f32 v39, v114, v115
  ds_write_b128 v146, v[36:39] offset:20480
  s_add_u32 s72, s71, 4228096
  buffer_load_dwordx4 v[100:103], v2, s[40:43], s72 offen sc1
  v_dot2_f32_bf16 v124, v36, s62, v124
  v_dot2_f32_bf16 v125, v36, v36, v125
  v_dot2_f32_bf16 v124, v37, s62, v124
  v_dot2_f32_bf16 v125, v37, v37, v125
  v_dot2_f32_bf16 v124, v38, s62, v124
  v_dot2_f32_bf16 v125, v38, v38, v125
  v_dot2_f32_bf16 v124, v39, s62, v124
  v_dot2_f32_bf16 v125, v39, v39, v125
  v_lshlrev_b32 v108, 16, v40
  v_and_b32 v109, s64, v40
  v_lshlrev_b32 v110, 16, v41
  v_and_b32 v111, s64, v41
  v_lshlrev_b32 v112, 16, v42
  v_and_b32 v113, s64, v42
  v_lshlrev_b32 v114, 16, v43
  v_and_b32 v115, s64, v43
  v_pk_fma_f32 v[116:117], v[108:109], v[10:11], v[10:11] op_sel:[0,0,1] op_sel_hi:[1,0,1]
  v_pk_fma_f32 v[118:119], v[110:111], v[10:11], v[10:11] op_sel:[0,0,1] op_sel_hi:[1,0,1]
  v_lshlrev_b32 v120, 16, v104
  v_and_b32 v121, s64, v104
  v_lshlrev_b32 v122, 16, v105
  v_and_b32 v123, s64, v105
  v_pk_fma_f32 v[108:109], v[116:117], v[120:121], v[108:109]
  v_pk_fma_f32 v[110:111], v[118:119], v[122:123], v[110:111]
  v_pk_fma_f32 v[116:117], v[112:113], v[10:11], v[10:11] op_sel:[0,0,1] op_sel_hi:[1,0,1]
  v_pk_fma_f32 v[118:119], v[114:115], v[10:11], v[10:11] op_sel:[0,0,1] op_sel_hi:[1,0,1]
  v_lshlrev_b32 v120, 16, v106
  v_and_b32 v121, s64, v106
  v_lshlrev_b32 v122, 16, v107
  v_and_b32 v123, s64, v107
  v_pk_fma_f32 v[112:113], v[116:117], v[120:121], v[112:113]
  v_pk_fma_f32 v[114:115], v[118:119], v[122:123], v[114:115]
  v_cvt_pk_bf16_f32 v40, v108, v109
  v_cvt_pk_bf16_f32 v41, v110, v111
  v_cvt_pk_bf16_f32 v42, v112, v113
  v_cvt_pk_bf16_f32 v43, v114, v115
  ds_write_b128 v146, v[40:43] offset:24576
  s_add_u32 s72, s71, 4229120
  buffer_load_dwordx4 v[104:107], v2, s[40:43], s72 offen sc1
  v_dot2_f32_bf16 v124, v40, s62, v124
  v_dot2_f32_bf16 v125, v40, v40, v125
  v_dot2_f32_bf16 v124, v41, s62, v124
  v_dot2_f32_bf16 v125, v41, v41, v125
  v_dot2_f32_bf16 v124, v42, s62, v124
  v_dot2_f32_bf16 v125, v42, v42, v125
  v_dot2_f32_bf16 v124, v43, s62, v124
  v_dot2_f32_bf16 v125, v43, v43, v125
  s_nop 1
  v_add_f32 v124, v124, v124 row_ror:8
  v_add_f32 v125, v125, v125 row_ror:8
  v_mov_b32 v126, v124
  v_mov_b32 v127, v125
  s_nop 0
  v_permlane16_swap_b32 v124, v126
  v_permlane16_swap_b32 v125, v127
  v_add_f32 v124, v124, v126
  v_add_f32 v125, v125, v127
  v_mov_b32 v126, v124
  v_mov_b32 v127, v125
  s_nop 0
  v_permlane32_swap_b32 v124, v126
  v_permlane32_swap_b32 v125, v127
  v_add_f32 v124, v124, v126
  v_add_f32 v125, v125, v127
  v_mul_f32 v124, s63, v124
  v_mul_f32 v126, v124, v124
  v_fma_f32 v125, s63, v125, -v126
  v_max_f32 v125, 0, v125
  v_cvt_pk_bf16_f32 v125, v125, v125
  v_lshlrev_b32 v125, 16, v125
  v_add_f32 v125, 0x3727c5ac, v125
  v_cvt_pk_bf16_f32 v125, v125, v125
  v_lshlrev_b32 v125, 16, v125
  v_sqrt_f32 v125, v125
  s_nop 0
  v_cvt_pk_bf16_f32 v125, v125, v125
  v_lshlrev_b32 v125, 16, v125
  v_rcp_f32 v127, v125
  v_cvt_pk_bf16_f32 v124, v124, v124
  v_lshlrev_b32 v124, 16, v124
  v_sub_f32 v126, 0, v124
  s_mov_b64 exec, 0xff
  ds_write_b64 v147, v[126:127] offset:0
  s_mov_b64 exec, -1
  s_waitcnt lgkmcnt(0)
  s_barrier
  ds_read_b128 v[132:135], v148 offset:0
  ds_read_b128 v[136:139], v148 offset:1024
  ds_read_b128 v[8:11], v149 offset:0
  ds_read_b64 v[156:157], v150 offset:0
  ds_read_b128 v[140:143], v148 offset:2048
  s_waitcnt lgkmcnt(4)
  v_mfma_f32_32x32x16_bf16 v[16:31], a[0:3], v[132:135], 0
  ds_read_b128 v[132:135], v148 offset:3072
  s_waitcnt lgkmcnt(4)
  v_mfma_f32_32x32x16_bf16 v[16:31], a[8:11], v[136:139], v[16:31]
  ds_read_b128 v[136:139], v148 offset:4096
  s_waitcnt lgkmcnt(2)
  v_mfma_f32_32x32x16_bf16 v[16:31], a[16:19], v[140:143], v[16:31]
  s_add_u32 s82, s69, 24576
  buffer_load_dwordx2 v[76:77], v145, s[40:43], s82 offen sc1
  ds_read_b128 v[140:143], v148 offset:5120
  s_waitcnt lgkmcnt(2)
  v_mfma_f32_32x32x16_bf16 v[16:31], a[24:27], v[132:135], v[16:31]
  ds_read_b128 v[132:135], v148 offset:6144
  s_waitcnt lgkmcnt(2)
  v_mfma_f32_32x32x16_bf16 v[16:31], a[32:35], v[136:139], v[16:31]
  ds_read_b128 v[136:139], v148 offset:7168
  s_waitcnt lgkmcnt(2)
  v_mfma_f32_32x32x16_bf16 v[16:31], a[40:43], v[140:143], v[16:31]
  ds_read_b128 v[140:143], v148 offset:8192
  s_waitcnt lgkmcnt(2)
  v_mfma_f32_32x32x16_bf16 v[16:31], a[48:51], v[132:135], v[16:31]
  ds_read_b128 v[132:135], v148 offset:9216
  s_waitcnt lgkmcnt(2)
  v_mfma_f32_32x32x16_bf16 v[16:31], a[56:59], v[136:139], v[16:31]
  ds_read_b128 v[136:139], v148 offset:10240
  s_waitcnt lgkmcnt(2)
  v_mfma_f32_32x32x16_bf16 v[16:31], a[64:67], v[140:143], v[16:31]
  ds_read_b128 v[140:143], v148 offset:11264
  s_waitcnt lgkmcnt(2)
  v_mfma_f32_32x32x16_bf16 v[16:31], a[72:75], v[132:135], v[16:31]
  ds_read_b128 v[132:135], v148 offset:12288
  s_waitcnt lgkmcnt(2)
  v_mfma_f32_32x32x16_bf16 v[16:31], a[80:83], v[136:139], v[16:31]
  ds_read_b128 v[136:139], v148 offset:13312
  s_waitcnt lgkmcnt(2)
  v_mfma_f32_32x32x16_bf16 v[16:31], a[88:91], v[140:143], v[16:31]
  ds_read_b128 v[140:143], v148 offset:14336
  s_waitcnt lgkmcnt(2)
  v_mfma_f32_32x32x16_bf16 v[16:31], a[96:99], v[132:135], v[16:31]
  ds_read_b128 v[132:135], v148 offset:15360
  s_waitcnt lgkmcnt(2)
  v_mfma_f32_32x32x16_bf16 v[16:31], a[104:107], v[136:139], v[16:31]
  ds_read_b128 v[136:139], v148 offset:16384
  s_waitcnt lgkmcnt(2)
  v_mfma_f32_32x32x16_bf16 v[16:31], a[112:115], v[140:143], v[16:31]
  ds_read_b128 v[140:143], v148 offset:17408
  s_waitcnt lgkmcnt(2)
  v_mfma_f32_32x32x16_bf16 v[16:31], a[120:123], v[132:135], v[16:31]
  ds_read_b128 v[132:135], v148 offset:18432
  s_waitcnt lgkmcnt(2)
  v_mfma_f32_32x32x16_bf16 v[16:31], a[128:131], v[136:139], v[16:31]
  ds_read_b128 v[136:139], v148 offset:19456
  s_waitcnt lgkmcnt(2)
  v_mfma_f32_32x32x16_bf16 v[16:31], a[136:139], v[140:143], v[16:31]
  ds_read_b128 v[140:143], v148 offset:20480
  s_waitcnt lgkmcnt(2)
  v_mfma_f32_32x32x16_bf16 v[16:31], a[144:147], v[132:135], v[16:31]
  ds_read_b128 v[132:135], v148 offset:21504
  s_waitcnt lgkmcnt(2)
  v_mfma_f32_32x32x16_bf16 v[16:31], a[152:155], v[136:139], v[16:31]
  ds_read_b128 v[136:139], v148 offset:22528
  s_waitcnt lgkmcnt(2)
  v_mfma_f32_32x32x16_bf16 v[16:31], a[160:163], v[140:143], v[16:31]
  ds_read_b128 v[140:143], v148 offset:23552
  s_waitcnt lgkmcnt(2)
  v_mfma_f32_32x32x16_bf16 v[16:31], a[168:171], v[132:135], v[16:31]
  ds_read_b128 v[132:135], v148 offset:24576
  s_waitcnt lgkmcnt(2)
  v_mfma_f32_32x32x16_bf16 v[16:31], a[176:179], v[136:139], v[16:31]
  s_waitcnt vmcnt(0)
PX1:
  v_xor_b32 v76, s66, v76
  v_xor_b32 v77, s67, v77
  v_or_b32 v76, v76, v77
  v_cmp_ne_u32 vcc, 0, v76
  s_nop 0
  s_cbranch_vccz PX1_D
  s_add_u32 s83, s83, 1
  s_cmp_gt_u32 s83, 0x40000
  s_cbranch_scc1 PX1_D
  s_sleep 4
  buffer_load_dwordx2 v[76:77], v145, s[40:43], s82 offen sc1
  s_waitcnt vmcnt(0)
  s_branch PX1
PX1_D:
  s_lshr_b32 s72, s71, 1
  s_add_u32 s72, s72, 9451520
  buffer_load_dwordx2 v[116:117], v144, s[40:43], s72 offen offset:0 sc1
  ds_read_b128 v[136:139], v148 offset:25600
  s_waitcnt lgkmcnt(2)
  v_mfma_f32_32x32x16_bf16 v[16:31], a[184:187], v[140:143], v[16:31]
  buffer_load_dwordx2 v[118:119], v144, s[40:43], s72 offen offset:512 sc1
  buffer_load_dwordx2 v[120:121], v144, s[40:43], s72 offen offset:1024 sc1
  buffer_load_dwordx2 v[122:123], v144, s[40:43], s72 offen offset:1536 sc1
  buffer_load_dwordx2 v[124:125], v144, s[40:43], s72 offen offset:2048 sc1
  ds_read_b128 v[140:143], v148 offset:26624
  s_waitcnt lgkmcnt(2)
  v_mfma_f32_32x32x16_bf16 v[16:31], a[192:195], v[132:135], v[16:31]
  buffer_load_dwordx2 v[126:127], v144, s[40:43], s72 offen offset:2560 sc1
  buffer_load_dwordx2 v[128:129], v144, s[40:43], s72 offen offset:3072 sc1
  s_add_u32 s72, s71, 6320128
  s_add_u32 s74, s71, 6324224
  ds_read_b128 v[132:135], v148 offset:27648
  s_waitcnt lgkmcnt(2)
  v_mfma_f32_32x32x16_bf16 v[16:31], a[200:203], v[136:139], v[16:31]
  buffer_load_dwordx4 v[48:51], v2, s[40:43], s72 offen offset:0 sc1
  buffer_load_dwordx4 v[52:55], v2, s[40:43], s72 offen offset:1024 sc1
  buffer_load_dwordx4 v[56:59], v2, s[40:43], s72 offen offset:2048 sc1
  buffer_load_dwordx4 v[60:63], v2, s[40:43], s72 offen offset:3072 sc1
  ds_read_b128 v[136:139], v148 offset:0
  s_waitcnt lgkmcnt(2)
  v_mfma_f32_32x32x16_bf16 v[16:31], a[208:211], v[140:143], v[16:31]
  buffer_load_dwordx4 v[64:67], v2, s[40:43], s74 offen offset:0 sc1
  buffer_load_dwordx4 v[68:71], v2, s[40:43], s74 offen offset:1024 sc1
  buffer_load_dwordx4 v[72:75], v2, s[40:43], s74 offen offset:2048 sc1
  ds_read_b128 v[140:143], v148 offset:1024
  s_waitcnt lgkmcnt(2)
  v_mfma_f32_32x32x16_bf16 v[16:31], a[216:219], v[132:135], v[16:31]
  ds_read_b128 v[132:135], v148 offset:2048
  s_waitcnt lgkmcnt(2)
  v_mfma_f32_32x32x16_bf16 v[32:47], a[4:7], v[136:139], 0
  ds_read_b128 v[136:139], v148 offset:3072
  s_waitcnt lgkmcnt(2)
  v_mfma_f32_32x32x16_bf16 v[32:47], a[12:15], v[140:143], v[32:47]
  s_add_u32 s73, s75, 25165824
  ds_read_b128 v[108:111], v151 offset:0
  ds_read_b128 v[112:115], v151 offset:16
  s_waitcnt lgkmcnt(0)
  ds_read_b128 v[140:143], v148 offset:4096
  v_mfma_f32_32x32x16_bf16 v[32:47], a[20:23], v[132:135], v[32:47]
  v_fmac_f32 v16, v108, v156
  v_fmac_f32 v17, v109, v156
  v_fmac_f32 v18, v110, v156
  v_fmac_f32 v19, v111, v156
  ds_read_b128 v[132:135], v148 offset:5120
  v_mfma_f32_32x32x16_bf16 v[32:47], a[28:31], v[136:139], v[32:47]
  v_fmac_f32 v20, v112, v156
  v_fmac_f32 v21, v113, v156
  v_fmac_f32 v22, v114, v156
  v_fmac_f32 v23, v115, v156
  ds_read_b128 v[136:139], v148 offset:6144
  s_waitcnt lgkmcnt(2)
  v_mfma_f32_32x32x16_bf16 v[32:47], a[36:39], v[140:143], v[32:47]
  ds_read_b128 v[108:111], v151 offset:32
  ds_read_b128 v[112:115], v151 offset:48
  s_waitcnt lgkmcnt(0)
  v_fmac_f32 v24, v108, v156
  ds_read_b128 v[140:143], v148 offset:7168
  v_mfma_f32_32x32x16_bf16 v[32:47], a[44:47], v[132:135], v[32:47]
  v_fmac_f32 v25, v109, v156
  v_fmac_f32 v26, v110, v156
  v_fmac_f32 v27, v111, v156
  v_fmac_f32 v28, v112, v156
  ds_read_b128 v[132:135], v148 offset:8192
  v_mfma_f32_32x32x16_bf16 v[32:47], a[52:55], v[136:139], v[32:47]
  v_fmac_f32 v29, v113, v156
  v_fmac_f32 v30, v114, v156
  v_fmac_f32 v31, v115, v156
  v_max_f32 v16, 0, v16
  ds_read_b128 v[136:139], v148 offset:9216
  s_waitcnt lgkmcnt(2)
  v_mfma_f32_32x32x16_bf16 v[32:47], a[60:63], v[140:143], v[32:47]
  v_max_f32 v17, 0, v17
  v_max_f32 v18, 0, v18
  v_max_f32 v19, 0, v19
  v_max_f32 v20, 0, v20
  ds_read_b128 v[140:143], v148 offset:10240
  s_waitcnt lgkmcnt(2)
  v_mfma_f32_32x32x16_bf16 v[32:47], a[68:71], v[132:135], v[32:47]
  v_max_f32 v21, 0, v21
  v_max_f32 v22, 0, v22
  v_max_f32 v23, 0, v23
  v_max_f32 v24, 0, v24
  ds_read_b128 v[132:135], v148 offset:11264
  s_waitcnt lgkmcnt(2)
  v_mfma_f32_32x32x16_bf16 v[32:47], a[76:79], v[136:139], v[32:47]
  v_max_f32 v25, 0, v25
  v_max_f32 v26, 0, v26
  v_max_f32 v27, 0, v27
  v_max_f32 v28, 0, v28
  ds_read_b128 v[136:139], v148 offset:12288
  s_waitcnt lgkmcnt(2)
  v_mfma_f32_32x32x16_bf16 v[32:47], a[84:87], v[140:143], v[32:47]
  v_max_f32 v29, 0, v29
  v_max_f32 v30, 0, v30
  v_max_f32 v31, 0, v31
  v_cvt_pk_bf16_f32 v16, v16, v17
  ds_read_b128 v[140:143], v148 offset:13312
  s_waitcnt lgkmcnt(2)
  v_mfma_f32_32x32x16_bf16 v[32:47], a[92:95], v[132:135], v[32:47]
  v_cvt_pk_bf16_f32 v17, v18, v19
  v_cvt_pk_bf16_f32 v18, v20, v21
  v_cvt_pk_bf16_f32 v19, v22, v23
  v_cvt_pk_bf16_f32 v20, v24, v25
  ds_read_b128 v[132:135], v148 offset:14336
  s_waitcnt lgkmcnt(2)
  v_mfma_f32_32x32x16_bf16 v[32:47], a[100:103], v[136:139], v[32:47]
  v_cvt_pk_bf16_f32 v21, v26, v27
  v_cvt_pk_bf16_f32 v22, v28, v29
  v_cvt_pk_bf16_f32 v23, v30, v31
  buffer_store_dwordx4 v[16:19], v2, s[40:43], s73 offen offset:0 sc1
  ds_read_b128 v[136:139], v148 offset:15360
  s_waitcnt lgkmcnt(2)
  v_mfma_f32_32x32x16_bf16 v[32:47], a[108:111], v[140:143], v[32:47]
  buffer_store_dwordx4 v[20:23], v2, s[40:43], s73 offen offset:1024 sc1
  ds_read_b128 v[140:143], v148 offset:16384
  s_waitcnt lgkmcnt(2)
  v_mfma_f32_32x32x16_bf16 v[32:47], a[116:119], v[132:135], v[32:47]
  ds_read_b128 v[132:135], v148 offset:17408
  s_waitcnt lgkmcnt(2)
  v_mfma_f32_32x32x16_bf16 v[32:47], a[124:127], v[136:139], v[32:47]
  ds_read_b128 v[136:139], v148 offset:18432
  s_waitcnt lgkmcnt(2)
  v_mfma_f32_32x32x16_bf16 v[32:47], a[132:135], v[140:143], v[32:47]
  ds_read_b128 v[140:143], v148 offset:19456
  s_waitcnt lgkmcnt(2)
  v_mfma_f32_32x32x16_bf16 v[32:47], a[140:143], v[132:135], v[32:47]
  ds_read_b128 v[132:135], v148 offset:20480
  s_waitcnt lgkmcnt(2)
  v_mfma_f32_32x32x16_bf16 v[32:47], a[148:151], v[136:139], v[32:47]
  ds_read_b128 v[136:139], v148 offset:21504
  s_waitcnt lgkmcnt(2)
  v_mfma_f32_32x32x16_bf16 v[32:47], a[156:159], v[140:143], v[32:47]
  ds_read_b128 v[140:143], v148 offset:22528
  s_waitcnt lgkmcnt(2)
  v_mfma_f32_32x32x16_bf16 v[32:47], a[164:167], v[132:135], v[32:47]
  ds_read_b128 v[132:135], v148 offset:23552
  s_waitcnt lgkmcnt(2)
  v_mfma_f32_32x32x16_bf16 v[32:47], a[172:175], v[136:139], v[32:47]
  ds_read_b128 v[136:139], v148 offset:24576
  s_waitcnt lgkmcnt(2)
  v_mfma_f32_32x32x16_bf16 v[32:47], a[180:183], v[140:143], v[32:47]
  ds_read_b128 v[140:143], v148 offset:25600
  s_waitcnt lgkmcnt(2)
  v_mfma_f32_32x32x16_bf16 v[32:47], a[188:191], v[132:135], v[32:47]
  ds_read_b128 v[132:135], v148 offset:26624
  s_waitcnt lgkmcnt(2)
  v_mfma_f32_32x32x16_bf16 v[32:47], a[196:199], v[136:139], v[32:47]
  ds_read_b128 v[136:139], v148 offset:27648
  s_waitcnt lgkmcnt(2)
  v_mfma_f32_32x32x16_bf16 v[32:47], a[204:207], v[140:143], v[32:47]
  s_waitcnt lgkmcnt(1)
  v_mfma_f32_32x32x16_bf16 v[32:47], a[212:215], v[132:135], v[32:47]
  s_waitcnt lgkmcnt(0)
  v_mfma_f32_32x32x16_bf16 v[32:47], a[220:223], v[136:139], v[32:47]
  s_add_u32 s73, s75, 25165824
  ds_read_b128 v[108:111], v151 offset:128
  ds_read_b128 v[112:115], v151 offset:144
  s_waitcnt lgkmcnt(0)
  s_nop 7
  v_fmac_f32 v32, v108, v156
  v_fmac_f32 v33, v109, v156
  v_fmac_f32 v34, v110, v156
  v_fmac_f32 v35, v111, v156
  v_fmac_f32 v36, v112, v156
  v_fmac_f32 v37, v113, v156
  v_fmac_f32 v38, v114, v156
  v_fmac_f32 v39, v115, v156
  ds_read_b128 v[108:111], v151 offset:160
  ds_read_b128 v[112:115], v151 offset:176
  s_waitcnt lgkmcnt(0)
  v_fmac_f32 v40, v108, v156
  v_fmac_f32 v41, v109, v156
  v_fmac_f32 v42, v110, v156
  v_fmac_f32 v43, v111, v156
  v_fmac_f32 v44, v112, v156
  v_fmac_f32 v45, v113, v156
  v_fmac_f32 v46, v114, v156
  v_fmac_f32 v47, v115, v156
  v_cvt_pk_bf16_f32 v32, v32, v33
  v_cvt_pk_bf16_f32 v33, v34, v35
  v_cvt_pk_bf16_f32 v34, v36, v37
  v_cvt_pk_bf16_f32 v35, v38, v39
  v_cvt_pk_bf16_f32 v36, v40, v41
  v_cvt_pk_bf16_f32 v37, v42, v43
  v_cvt_pk_bf16_f32 v38, v44, v45
  v_cvt_pk_bf16_f32 v39, v46, v47
  v_pk_max_i16 v32, v32, 0
  v_pk_max_i16 v33, v33, 0
  v_pk_max_i16 v34, v34, 0
  v_pk_max_i16 v35, v35, 0
  v_pk_max_i16 v36, v36, 0
  v_pk_max_i16 v37, v37, 0
  v_pk_max_i16 v38, v38, 0
  v_pk_max_i16 v39, v39, 0
  buffer_store_dwordx4 v[32:35], v2, s[40:43], s73 offen offset:2048 sc1
  buffer_store_dwordx4 v[36:39], v2, s[40:43], s73 offen offset:3072 sc1
  s_waitcnt vmcnt(11)
  v_add_f32 v130, v116, v118
  v_add_f32 v77, v117, v119
  v_add_f32 v130, v130, v120
  v_add_f32 v77, v77, v121
  v_add_f32 v130, v130, v122
  v_add_f32 v77, v77, v123
  v_add_f32 v130, v130, v124
  v_add_f32 v77, v77, v125
  v_add_f32 v130, v130, v126
  v_add_f32 v77, v77, v127
  v_add_f32 v130, v130, v128
  v_add_f32 v77, v77, v129
  s_nop 0
  v_add_f32 v130, v130, v130 row_ror:8
  v_mov_b32 v131, v130
  s_nop 1
  v_permlane16_swap_b32 v130, v131
  v_add_f32 v130, v130, v131
  v_mov_b32 v131, v130
  s_nop 1
  v_permlane32_swap_b32 v130, v131
  v_add_f32 v130, v130, v131
  v_mul_f32 v130, s63, v130
  v_mul_f32 v131, 0xc1000000, v130
  v_add_f32 v116, v116, v131
  v_add_f32 v118, v118, v131
  v_add_f32 v120, v120, v131
  v_add_f32 v122, v122, v131
  v_add_f32 v124, v124, v131
  v_add_f32 v126, v126, v131
  v_add_f32 v128, v128, v131
  v_mul_f32 v76, v116, v116
  v_fmac_f32 v76, v118, v118
  v_fmac_f32 v76, v120, v120
  v_fmac_f32 v76, v122, v122
  v_fmac_f32 v76, v124, v124
  v_fmac_f32 v76, v126, v126
  v_fmac_f32 v76, v128, v128
  v_fmac_f32 v77, 0x3e000000, v76
  v_cvt_pk_bf16_f32 v12, v130, v130
  v_lshlrev_b32 v12, 16, v12
  v_add_f32 v77, v77, v77 row_ror:8
  v_mov_b32 v131, v77
  s_nop 1
  v_permlane16_swap_b32 v77, v131
  v_add_f32 v77, v77, v131
  v_mov_b32 v131, v77
  s_nop 1
  v_permlane32_swap_b32 v77, v131
  v_add_f32 v77, v77, v131
  v_mul_f32 v77, s63, v77
  v_max_f32 v77, 0, v77
  v_cvt_pk_bf16_f32 v77, v77, v77
  v_lshlrev_b32 v77, 16, v77
  v_add_f32 v77, 0x3727c5ac, v77
  v_cvt_pk_bf16_f32 v77, v77, v77
  v_lshlrev_b32 v77, 16, v77
  v_sqrt_f32 v77, v77
  s_nop 0
  v_cvt_pk_bf16_f32 v77, v77, v77
  v_lshlrev_b32 v77, 16, v77
  v_rcp_f32 v14, v77
  s_nop 0
  v_mul_f32 v15, v12, v14
  v_sub_f32 v15, 0, v15
  s_waitcnt vmcnt(4)
  v_lshlrev_b32 v108, 16, v48
  v_and_b32 v109, s64, v48
  v_lshlrev_b32 v110, 16, v49
  v_and_b32 v111, s64, v49
  v_lshlrev_b32 v112, 16, v50
  v_and_b32 v113, s64, v50
  v_lshlrev_b32 v114, 16, v51
  v_and_b32 v115, s64, v51
  v_pk_fma_f32 v[116:117], v[108:109], v[14:15], v[14:15] op_sel:[0,0,1] op_sel_hi:[1,0,1]
  v_pk_fma_f32 v[118:119], v[110:111], v[14:15], v[14:15] op_sel:[0,0,1] op_sel_hi:[1,0,1]
  v_lshlrev_b32 v120, 16, v80
  v_and_b32 v121, s64, v80
  v_lshlrev_b32 v122, 16, v81
  v_and_b32 v123, s64, v81
  v_pk_fma_f32 v[108:109], v[116:117], v[120:121], v[108:109]
  v_pk_fma_f32 v[110:111], v[118:119], v[122:123], v[110:111]
  v_pk_fma_f32 v[116:117], v[112:113], v[14:15], v[14:15] op_sel:[0,0,1] op_sel_hi:[1,0,1]
  v_pk_fma_f32 v[118:119], v[114:115], v[14:15], v[14:15] op_sel:[0,0,1] op_sel_hi:[1,0,1]
  v_lshlrev_b32 v120, 16, v82
  v_and_b32 v121, s64, v82
  v_lshlrev_b32 v122, 16, v83
  v_and_b32 v123, s64, v83
  v_pk_fma_f32 v[112:113], v[116:117], v[120:121], v[112:113]
  v_pk_fma_f32 v[114:115], v[118:119], v[122:123], v[114:115]
  v_cvt_pk_bf16_f32 v48, v108, v109
  v_cvt_pk_bf16_f32 v49, v110, v111
  v_cvt_pk_bf16_f32 v50, v112, v113
  v_cvt_pk_bf16_f32 v51, v114, v115
  ds_write_b128 v146, v[48:51] offset:28736
  v_dot2_f32_bf16 v124, v48, s62, 0
  v_dot2_f32_bf16 v125, v48, v48, 0
  v_dot2_f32_bf16 v124, v49, s62, v124
  v_dot2_f32_bf16 v125, v49, v49, v125
  v_dot2_f32_bf16 v124, v50, s62, v124
  v_dot2_f32_bf16 v125, v50, v50, v125
  v_dot2_f32_bf16 v124, v51, s62, v124
  v_dot2_f32_bf16 v125, v51, v51, v125
  v_lshlrev_b32 v108, 16, v52
  v_and_b32 v109, s64, v52
  v_lshlrev_b32 v110, 16, v53
  v_and_b32 v111, s64, v53
  v_lshlrev_b32 v112, 16, v54
  v_and_b32 v113, s64, v54
  v_lshlrev_b32 v114, 16, v55
  v_and_b32 v115, s64, v55
  v_pk_fma_f32 v[116:117], v[108:109], v[14:15], v[14:15] op_sel:[0,0,1] op_sel_hi:[1,0,1]
  v_pk_fma_f32 v[118:119], v[110:111], v[14:15], v[14:15] op_sel:[0,0,1] op_sel_hi:[1,0,1]
  v_lshlrev_b32 v120, 16, v84
  v_and_b32 v121, s64, v84
  v_lshlrev_b32 v122, 16, v85
  v_and_b32 v123, s64, v85
  v_pk_fma_f32 v[108:109], v[116:117], v[120:121], v[108:109]
  v_pk_fma_f32 v[110:111], v[118:119], v[122:123], v[110:111]
  v_pk_fma_f32 v[116:117], v[112:113], v[14:15], v[14:15] op_sel:[0,0,1] op_sel_hi:[1,0,1]
  v_pk_fma_f32 v[118:119], v[114:115], v[14:15], v[14:15] op_sel:[0,0,1] op_sel_hi:[1,0,1]
  v_lshlrev_b32 v120, 16, v86
  v_and_b32 v121, s64, v86
  v_lshlrev_b32 v122, 16, v87
  v_and_b32 v123, s64, v87
  v_pk_fma_f32 v[112:113], v[116:117], v[120:121], v[112:113]
  v_pk_fma_f32 v[114:115], v[118:119], v[122:123], v[114:115]
  v_cvt_pk_bf16_f32 v52, v108, v109
  v_cvt_pk_bf16_f32 v53, v110, v111
  v_cvt_pk_bf16_f32 v54, v112, v113
  v_cvt_pk_bf16_f32 v55, v114, v115
  ds_write_b128 v146, v[52:55] offset:32832
  v_dot2_f32_bf16 v124, v52, s62, v124
  v_dot2_f32_bf16 v125, v52, v52, v125
  v_dot2_f32_bf16 v124, v53, s62, v124
  v_dot2_f32_bf16 v125, v53, v53, v125
  v_dot2_f32_bf16 v124, v54, s62, v124
  v_dot2_f32_bf16 v125, v54, v54, v125
  v_dot2_f32_bf16 v124, v55, s62, v124
  v_dot2_f32_bf16 v125, v55, v55, v125
  v_lshlrev_b32 v108, 16, v56
  v_and_b32 v109, s64, v56
  v_lshlrev_b32 v110, 16, v57
  v_and_b32 v111, s64, v57
  v_lshlrev_b32 v112, 16, v58
  v_and_b32 v113, s64, v58
  v_lshlrev_b32 v114, 16, v59
  v_and_b32 v115, s64, v59
  v_pk_fma_f32 v[116:117], v[108:109], v[14:15], v[14:15] op_sel:[0,0,1] op_sel_hi:[1,0,1]
  v_pk_fma_f32 v[118:119], v[110:111], v[14:15], v[14:15] op_sel:[0,0,1] op_sel_hi:[1,0,1]
  v_lshlrev_b32 v120, 16, v88
  v_and_b32 v121, s64, v88
  v_lshlrev_b32 v122, 16, v89
  v_and_b32 v123, s64, v89
  v_pk_fma_f32 v[108:109], v[116:117], v[120:121], v[108:109]
  v_pk_fma_f32 v[110:111], v[118:119], v[122:123], v[110:111]
  v_pk_fma_f32 v[116:117], v[112:113], v[14:15], v[14:15] op_sel:[0,0,1] op_sel_hi:[1,0,1]
  v_pk_fma_f32 v[118:119], v[114:115], v[14:15], v[14:15] op_sel:[0,0,1] op_sel_hi:[1,0,1]
  v_lshlrev_b32 v120, 16, v90
  v_and_b32 v121, s64, v90
  v_lshlrev_b32 v122, 16, v91
  v_and_b32 v123, s64, v91
  v_pk_fma_f32 v[112:113], v[116:117], v[120:121], v[112:113]
  v_pk_fma_f32 v[114:115], v[118:119], v[122:123], v[114:115]
  v_cvt_pk_bf16_f32 v56, v108, v109
  v_cvt_pk_bf16_f32 v57, v110, v111
  v_cvt_pk_bf16_f32 v58, v112, v113
  v_cvt_pk_bf16_f32 v59, v114, v115
  ds_write_b128 v146, v[56:59] offset:36928
  v_dot2_f32_bf16 v124, v56, s62, v124
  v_dot2_f32_bf16 v125, v56, v56, v125
  v_dot2_f32_bf16 v124, v57, s62, v124
  v_dot2_f32_bf16 v125, v57, v57, v125
  v_dot2_f32_bf16 v124, v58, s62, v124
  v_dot2_f32_bf16 v125, v58, v58, v125
  v_dot2_f32_bf16 v124, v59, s62, v124
  v_dot2_f32_bf16 v125, v59, v59, v125
  v_lshlrev_b32 v108, 16, v60
  v_and_b32 v109, s64, v60
  v_lshlrev_b32 v110, 16, v61
  v_and_b32 v111, s64, v61
  v_lshlrev_b32 v112, 16, v62
  v_and_b32 v113, s64, v62
  v_lshlrev_b32 v114, 16, v63
  v_and_b32 v115, s64, v63
  v_pk_fma_f32 v[116:117], v[108:109], v[14:15], v[14:15] op_sel:[0,0,1] op_sel_hi:[1,0,1]
  v_pk_fma_f32 v[118:119], v[110:111], v[14:15], v[14:15] op_sel:[0,0,1] op_sel_hi:[1,0,1]
  v_lshlrev_b32 v120, 16, v92
  v_and_b32 v121, s64, v92
  v_lshlrev_b32 v122, 16, v93
  v_and_b32 v123, s64, v93
  v_pk_fma_f32 v[108:109], v[116:117], v[120:121], v[108:109]
  v_pk_fma_f32 v[110:111], v[118:119], v[122:123], v[110:111]
  v_pk_fma_f32 v[116:117], v[112:113], v[14:15], v[14:15] op_sel:[0,0,1] op_sel_hi:[1,0,1]
  v_pk_fma_f32 v[118:119], v[114:115], v[14:15], v[14:15] op_sel:[0,0,1] op_sel_hi:[1,0,1]
  v_lshlrev_b32 v120, 16, v94
  v_and_b32 v121, s64, v94
  v_lshlrev_b32 v122, 16, v95
  v_and_b32 v123, s64, v95
  v_pk_fma_f32 v[112:113], v[116:117], v[120:121], v[112:113]
  v_pk_fma_f32 v[114:115], v[118:119], v[122:123], v[114:115]
  v_cvt_pk_bf16_f32 v60, v108, v109
  v_cvt_pk_bf16_f32 v61, v110, v111
  v_cvt_pk_bf16_f32 v62, v112, v113
  v_cvt_pk_bf16_f32 v63, v114, v115
  ds_write_b128 v146, v[60:63] offset:41024
  v_dot2_f32_bf16 v124, v60, s62, v124
  v_dot2_f32_bf16 v125, v60, v60, v125
  v_dot2_f32_bf16 v124, v61, s62, v124
  v_dot2_f32_bf16 v125, v61, v61, v125
  v_dot2_f32_bf16 v124, v62, s62, v124
  v_dot2_f32_bf16 v125, v62, v62, v125
  v_dot2_f32_bf16 v124, v63, s62, v124
  v_dot2_f32_bf16 v125, v63, v63, v125
  v_lshlrev_b32 v108, 16, v64
  v_and_b32 v109, s64, v64
  v_lshlrev_b32 v110, 16, v65
  s_waitcnt vmcnt(0)
  s_add_u32 s81, s76, 32768
  s_mov_b64 exec, 1
  buffer_store_dwordx2 v[4:5], v0, s[40:43], s81 offen sc1
  s_mov_b64 exec, -1
  v_and_b32 v111, s64, v65
  v_lshlrev_b32 v112, 16, v66
  v_and_b32 v113, s64, v66
  v_lshlrev_b32 v114, 16, v67
  v_and_b32 v115, s64, v67
  v_pk_fma_f32 v[116:117], v[108:109], v[14:15], v[14:15] op_sel:[0,0,1] op_sel_hi:[1,0,1]
  v_pk_fma_f32 v[118:119], v[110:111], v[14:15], v[14:15] op_sel:[0,0,1] op_sel_hi:[1,0,1]
  v_lshlrev_b32 v120, 16, v96
  v_and_b32 v121, s64, v96
  v_lshlrev_b32 v122, 16, v97
  v_and_b32 v123, s64, v97
  v_pk_fma_f32 v[108:109], v[116:117], v[120:121], v[108:109]
  v_pk_fma_f32 v[110:111], v[118:119], v[122:123], v[110:111]
  v_pk_fma_f32 v[116:117], v[112:113], v[14:15], v[14:15] op_sel:[0,0,1] op_sel_hi:[1,0,1]
  v_pk_fma_f32 v[118:119], v[114:115], v[14:15], v[14:15] op_sel:[0,0,1] op_sel_hi:[1,0,1]
  v_lshlrev_b32 v120, 16, v98
  v_and_b32 v121, s64, v98
  v_lshlrev_b32 v122, 16, v99
  v_and_b32 v123, s64, v99
  v_pk_fma_f32 v[112:113], v[116:117], v[120:121], v[112:113]
  v_pk_fma_f32 v[114:115], v[118:119], v[122:123], v[114:115]
  v_cvt_pk_bf16_f32 v64, v108, v109
  v_cvt_pk_bf16_f32 v65, v110, v111
  v_cvt_pk_bf16_f32 v66, v112, v113
  v_cvt_pk_bf16_f32 v67, v114, v115
  ds_write_b128 v146, v[64:67] offset:45120
  v_dot2_f32_bf16 v124, v64, s62, v124
  v_dot2_f32_bf16 v125, v64, v64, v125
  v_dot2_f32_bf16 v124, v65, s62, v124
  v_dot2_f32_bf16 v125, v65, v65, v125
  v_dot2_f32_bf16 v124, v66, s62, v124
  v_dot2_f32_bf16 v125, v66, v66, v125
  v_dot2_f32_bf16 v124, v67, s62, v124
  v_dot2_f32_bf16 v125, v67, v67, v125
  v_lshlrev_b32 v108, 16, v68
  v_and_b32 v109, s64, v68
  v_lshlrev_b32 v110, 16, v69
  v_and_b32 v111, s64, v69
  v_lshlrev_b32 v112, 16, v70
  v_and_b32 v113, s64, v70
  v_lshlrev_b32 v114, 16, v71
  v_and_b32 v115, s64, v71
  v_pk_fma_f32 v[116:117], v[108:109], v[14:15], v[14:15] op_sel:[0,0,1] op_sel_hi:[1,0,1]
  v_pk_fma_f32 v[118:119], v[110:111], v[14:15], v[14:15] op_sel:[0,0,1] op_sel_hi:[1,0,1]
  v_lshlrev_b32 v120, 16, v100
  v_and_b32 v121, s64, v100
  v_lshlrev_b32 v122, 16, v101
  v_and_b32 v123, s64, v101
  v_pk_fma_f32 v[108:109], v[116:117], v[120:121], v[108:109]
  v_pk_fma_f32 v[110:111], v[118:119], v[122:123], v[110:111]
  v_pk_fma_f32 v[116:117], v[112:113], v[14:15], v[14:15] op_sel:[0,0,1] op_sel_hi:[1,0,1]
  v_pk_fma_f32 v[118:119], v[114:115], v[14:15], v[14:15] op_sel:[0,0,1] op_sel_hi:[1,0,1]
  v_lshlrev_b32 v120, 16, v102
  v_and_b32 v121, s64, v102
  v_lshlrev_b32 v122, 16, v103
  v_and_b32 v123, s64, v103
  v_pk_fma_f32 v[112:113], v[116:117], v[120:121], v[112:113]
  v_pk_fma_f32 v[114:115], v[118:119], v[122:123], v[114:115]
  v_cvt_pk_bf16_f32 v68, v108, v109
  v_cvt_pk_bf16_f32 v69, v110, v111
  v_cvt_pk_bf16_f32 v70, v112, v113
  v_cvt_pk_bf16_f32 v71, v114, v115
  ds_write_b128 v146, v[68:71] offset:49216
  v_dot2_f32_bf16 v124, v68, s62, v124
  v_dot2_f32_bf16 v125, v68, v68, v125
  v_dot2_f32_bf16 v124, v69, s62, v124
  v_dot2_f32_bf16 v125, v69, v69, v125
  v_dot2_f32_bf16 v124, v70, s62, v124
  v_dot2_f32_bf16 v125, v70, v70, v125
  v_dot2_f32_bf16 v124, v71, s62, v124
  v_dot2_f32_bf16 v125, v71, v71, v125
  v_lshlrev_b32 v108, 16, v72
  v_and_b32 v109, s64, v72
  v_lshlrev_b32 v110, 16, v73
  v_and_b32 v111, s64, v73
  v_lshlrev_b32 v112, 16, v74
  v_and_b32 v113, s64, v74
  v_lshlrev_b32 v114, 16, v75
  v_and_b32 v115, s64, v75
  v_pk_fma_f32 v[116:117], v[108:109], v[14:15], v[14:15] op_sel:[0,0,1] op_sel_hi:[1,0,1]
  v_pk_fma_f32 v[118:119], v[110:111], v[14:15], v[14:15] op_sel:[0,0,1] op_sel_hi:[1,0,1]
  v_lshlrev_b32 v120, 16, v104
  v_and_b32 v121, s64, v104
  v_lshlrev_b32 v122, 16, v105
  v_and_b32 v123, s64, v105
  v_pk_fma_f32 v[108:109], v[116:117], v[120:121], v[108:109]
  v_pk_fma_f32 v[110:111], v[118:119], v[122:123], v[110:111]
  v_pk_fma_f32 v[116:117], v[112:113], v[14:15], v[14:15] op_sel:[0,0,1] op_sel_hi:[1,0,1]
  v_pk_fma_f32 v[118:119], v[114:115], v[14:15], v[14:15] op_sel:[0,0,1] op_sel_hi:[1,0,1]
  v_lshlrev_b32 v120, 16, v106
  v_and_b32 v121, s64, v106
  v_lshlrev_b32 v122, 16, v107
  v_and_b32 v123, s64, v107
  v_pk_fma_f32 v[112:113], v[116:117], v[120:121], v[112:113]
  v_pk_fma_f32 v[114:115], v[118:119], v[122:123], v[114:115]
  v_cvt_pk_bf16_f32 v72, v108, v109
  v_cvt_pk_bf16_f32 v73, v110, v111
  v_cvt_pk_bf16_f32 v74, v112, v113
  v_cvt_pk_bf16_f32 v75, v114, v115
  ds_write_b128 v146, v[72:75] offset:53312
  v_dot2_f32_bf16 v124, v72, s62, v124
  v_dot2_f32_bf16 v125, v72, v72, v125
  v_dot2_f32_bf16 v124, v73, s62, v124
  v_dot2_f32_bf16 v125, v73, v73, v125
  v_dot2_f32_bf16 v124, v74, s62, v124
  v_dot2_f32_bf16 v125, v74, v74, v125
  v_dot2_f32_bf16 v124, v75, s62, v124
  v_dot2_f32_bf16 v125, v75, v75, v125
  s_nop 1
  v_add_f32 v124, v124, v124 row_ror:8
  v_add_f32 v125, v125, v125 row_ror:8
  v_mov_b32 v126, v124
  v_mov_b32 v127, v125
  s_nop 0
  v_permlane16_swap_b32 v124, v126
  v_permlane16_swap_b32 v125, v127
  v_add_f32 v124, v124, v126
  v_add_f32 v125, v125, v127
  v_mov_b32 v126, v124
  v_mov_b32 v127, v125
  s_nop 0
  v_permlane32_swap_b32 v124, v126
  v_permlane32_swap_b32 v125, v127
  v_add_f32 v124, v124, v126
  v_add_f32 v125, v125, v127
  v_mul_f32 v124, s63, v124
  v_mul_f32 v126, v124, v124
  v_fma_f32 v125, s63, v125, -v126
  v_max_f32 v125, 0, v125
  v_cvt_pk_bf16_f32 v125, v125, v125
  v_lshlrev_b32 v125, 16, v125
  v_add_f32 v125, 0x3727c5ac, v125
  v_cvt_pk_bf16_f32 v125, v125, v125
  v_lshlrev_b32 v125, 16, v125
  v_sqrt_f32 v125, v125
  s_nop 0
  v_cvt_pk_bf16_f32 v125, v125, v125
  v_lshlrev_b32 v125, 16, v125
  v_rcp_f32 v127, v125
  v_cvt_pk_bf16_f32 v124, v124, v124
  v_lshlrev_b32 v124, 16, v124
  v_sub_f32 v126, 0, v124
  s_mov_b64 exec, 0xff
  ds_write_b64 v147, v[126:127] offset:256
  s_mov_b64 exec, -1
  s_waitcnt lgkmcnt(0)
  s_barrier
  ds_read_b128 v[132:135], v148 offset:28736
  ds_read_b128 v[136:139], v148 offset:29760
  ds_read_b128 v[12:15], v149 offset:28736
  ds_read_b64 v[158:159], v150 offset:256
  ds_read_b128 v[140:143], v148 offset:30784
  s_waitcnt lgkmcnt(4)
  v_mfma_f32_32x32x16_bf16 v[48:63], a[0:3], v[132:135], 0
  ds_read_b128 v[132:135], v148 offset:31808
  s_waitcnt lgkmcnt(4)
  v_mfma_f32_32x32x16_bf16 v[48:63], a[8:11], v[136:139], v[48:63]
  ds_read_b128 v[136:139], v148 offset:32832
  s_waitcnt lgkmcnt(2)
  v_mfma_f32_32x32x16_bf16 v[48:63], a[16:19], v[140:143], v[48:63]
  ds_read_b128 v[140:143], v148 offset:33856
  s_waitcnt lgkmcnt(2)
  v_mfma_f32_32x32x16_bf16 v[48:63], a[24:27], v[132:135], v[48:63]
  ds_read_b128 v[132:135], v148 offset:34880
  s_waitcnt lgkmcnt(2)
  v_mfma_f32_32x32x16_bf16 v[48:63], a[32:35], v[136:139], v[48:63]
  ds_read_b128 v[136:139], v148 offset:35904
  s_waitcnt lgkmcnt(2)
  v_mfma_f32_32x32x16_bf16 v[48:63], a[40:43], v[140:143], v[48:63]
  ds_read_b128 v[140:143], v148 offset:36928
  s_waitcnt lgkmcnt(2)
  v_mfma_f32_32x32x16_bf16 v[48:63], a[48:51], v[132:135], v[48:63]
  ds_read_b128 v[132:135], v148 offset:37952
  s_waitcnt lgkmcnt(2)
  v_mfma_f32_32x32x16_bf16 v[48:63], a[56:59], v[136:139], v[48:63]
  ds_read_b128 v[136:139], v148 offset:38976
  s_waitcnt lgkmcnt(2)
  v_mfma_f32_32x32x16_bf16 v[48:63], a[64:67], v[140:143], v[48:63]
  ds_read_b128 v[140:143], v148 offset:40000
  s_waitcnt lgkmcnt(2)
  v_mfma_f32_32x32x16_bf16 v[48:63], a[72:75], v[132:135], v[48:63]
  ds_read_b128 v[132:135], v148 offset:41024
  s_waitcnt lgkmcnt(2)
  v_mfma_f32_32x32x16_bf16 v[48:63], a[80:83], v[136:139], v[48:63]
  ds_read_b128 v[136:139], v148 offset:42048
  s_waitcnt lgkmcnt(2)
  v_mfma_f32_32x32x16_bf16 v[48:63], a[88:91], v[140:143], v[48:63]
  ds_read_b128 v[140:143], v148 offset:43072
  s_waitcnt lgkmcnt(2)
  v_mfma_f32_32x32x16_bf16 v[48:63], a[96:99], v[132:135], v[48:63]
  ds_read_b128 v[132:135], v148 offset:44096
  s_waitcnt lgkmcnt(2)
  v_mfma_f32_32x32x16_bf16 v[48:63], a[104:107], v[136:139], v[48:63]
  ds_read_b128 v[136:139], v148 offset:45120
  s_waitcnt lgkmcnt(2)
  v_mfma_f32_32x32x16_bf16 v[48:63], a[112:115], v[140:143], v[48:63]
  ds_read_b128 v[140:143], v148 offset:46144
  s_waitcnt lgkmcnt(2)
  v_mfma_f32_32x32x16_bf16 v[48:63], a[120:123], v[132:135], v[48:63]
  ds_read_b128 v[132:135], v148 offset:47168
  s_waitcnt lgkmcnt(2)
  v_mfma_f32_32x32x16_bf16 v[48:63], a[128:131], v[136:139], v[48:63]
  ds_read_b128 v[136:139], v148 offset:48192
  s_waitcnt lgkmcnt(2)
  v_mfma_f32_32x32x16_bf16 v[48:63], a[136:139], v[140:143], v[48:63]
  ds_read_b128 v[140:143], v148 offset:49216
  s_waitcnt lgkmcnt(2)
  v_mfma_f32_32x32x16_bf16 v[48:63], a[144:147], v[132:135], v[48:63]
  ds_read_b128 v[132:135], v148 offset:50240
  s_waitcnt lgkmcnt(2)
  v_mfma_f32_32x32x16_bf16 v[48:63], a[152:155], v[136:139], v[48:63]
  ds_read_b128 v[136:139], v148 offset:51264
  s_waitcnt lgkmcnt(2)
  v_mfma_f32_32x32x16_bf16 v[48:63], a[160:163], v[140:143], v[48:63]
  s_add_u32 s82, s69, 32768
  buffer_load_dwordx2 v[126:127], v145, s[40:43], s82 offen sc1
  ds_read_b128 v[140:143], v148 offset:52288
  s_waitcnt lgkmcnt(2)
  v_mfma_f32_32x32x16_bf16 v[48:63], a[168:171], v[132:135], v[48:63]
  ds_read_b128 v[132:135], v148 offset:53312
  s_waitcnt lgkmcnt(2)
  v_mfma_f32_32x32x16_bf16 v[48:63], a[176:179], v[136:139], v[48:63]
  ds_read_b128 v[136:139], v148 offset:54336
  s_waitcnt lgkmcnt(2)
  v_mfma_f32_32x32x16_bf16 v[48:63], a[184:187], v[140:143], v[48:63]
  ds_read_b128 v[140:143], v148 offset:55360
  s_waitcnt lgkmcnt(2)
  v_mfma_f32_32x32x16_bf16 v[48:63], a[192:195], v[132:135], v[48:63]
  ds_read_b128 v[132:135], v148 offset:56384
  s_waitcnt lgkmcnt(2)
  v_mfma_f32_32x32x16_bf16 v[48:63], a[200:203], v[136:139], v[48:63]
  ds_read_b128 v[136:139], v148 offset:28736
  s_waitcnt lgkmcnt(2)
  v_mfma_f32_32x32x16_bf16 v[48:63], a[208:211], v[140:143], v[48:63]
  ds_read_b128 v[140:143], v148 offset:29760
  s_waitcnt lgkmcnt(2)
  v_mfma_f32_32x32x16_bf16 v[48:63], a[216:219], v[132:135], v[48:63]
  ds_read_b128 v[132:135], v148 offset:30784
  s_waitcnt lgkmcnt(2)
  v_mfma_f32_32x32x16_bf16 v[64:79], a[4:7], v[136:139], 0
  ds_read_b128 v[136:139], v148 offset:31808
  s_waitcnt lgkmcnt(2)
  v_mfma_f32_32x32x16_bf16 v[64:79], a[12:15], v[140:143], v[64:79]
  s_add_u32 s73, s75, 25280512
  ds_read_b128 v[108:111], v151 offset:0
  ds_read_b128 v[112:115], v151 offset:16
  s_waitcnt lgkmcnt(0)
  ds_read_b128 v[140:143], v148 offset:32832
  v_mfma_f32_32x32x16_bf16 v[64:79], a[20:23], v[132:135], v[64:79]
  v_fmac_f32 v48, v108, v158
  v_fmac_f32 v49, v109, v158
  v_fmac_f32 v50, v110, v158
  v_fmac_f32 v51, v111, v158
  ds_read_b128 v[132:135], v148 offset:33856
  v_mfma_f32_32x32x16_bf16 v[64:79], a[28:31], v[136:139], v[64:79]
  v_fmac_f32 v52, v112, v158
  v_fmac_f32 v53, v113, v158
  v_fmac_f32 v54, v114, v158
  v_fmac_f32 v55, v115, v158
  ds_read_b128 v[136:139], v148 offset:34880
  s_waitcnt lgkmcnt(2)
  v_mfma_f32_32x32x16_bf16 v[64:79], a[36:39], v[140:143], v[64:79]
  ds_read_b128 v[108:111], v151 offset:32
  ds_read_b128 v[112:115], v151 offset:48
  s_waitcnt lgkmcnt(0)
  v_fmac_f32 v56, v108, v158
  ds_read_b128 v[140:143], v148 offset:35904
  v_mfma_f32_32x32x16_bf16 v[64:79], a[44:47], v[132:135], v[64:79]
  v_fmac_f32 v57, v109, v158
  v_fmac_f32 v58, v110, v158
  v_fmac_f32 v59, v111, v158
  v_fmac_f32 v60, v112, v158
  ds_read_b128 v[132:135], v148 offset:36928
  v_mfma_f32_32x32x16_bf16 v[64:79], a[52:55], v[136:139], v[64:79]
  v_fmac_f32 v61, v113, v158
  v_fmac_f32 v62, v114, v158
  v_fmac_f32 v63, v115, v158
  v_max_f32 v48, 0, v48
  ds_read_b128 v[136:139], v148 offset:37952
  s_waitcnt lgkmcnt(2)
  v_mfma_f32_32x32x16_bf16 v[64:79], a[60:63], v[140:143], v[64:79]
  v_max_f32 v49, 0, v49
  v_max_f32 v50, 0, v50
  v_max_f32 v51, 0, v51
  v_max_f32 v52, 0, v52
  ds_read_b128 v[140:143], v148 offset:38976
  s_waitcnt lgkmcnt(2)
  v_mfma_f32_32x32x16_bf16 v[64:79], a[68:71], v[132:135], v[64:79]
  v_max_f32 v53, 0, v53
  v_max_f32 v54, 0, v54
  v_max_f32 v55, 0, v55
  v_max_f32 v56, 0, v56
  ds_read_b128 v[132:135], v148 offset:40000
  s_waitcnt lgkmcnt(2)
  v_mfma_f32_32x32x16_bf16 v[64:79], a[76:79], v[136:139], v[64:79]
  v_max_f32 v57, 0, v57
  v_max_f32 v58, 0, v58
  v_max_f32 v59, 0, v59
  v_max_f32 v60, 0, v60
  ds_read_b128 v[136:139], v148 offset:41024
  s_waitcnt lgkmcnt(2)
  v_mfma_f32_32x32x16_bf16 v[64:79], a[84:87], v[140:143], v[64:79]
  v_max_f32 v61, 0, v61
  v_max_f32 v62, 0, v62
  v_max_f32 v63, 0, v63
  v_cvt_pk_bf16_f32 v48, v48, v49
  ds_read_b128 v[140:143], v148 offset:42048
  s_waitcnt lgkmcnt(2)
  v_mfma_f32_32x32x16_bf16 v[64:79], a[92:95], v[132:135], v[64:79]
  v_cvt_pk_bf16_f32 v49, v50, v51
  v_cvt_pk_bf16_f32 v50, v52, v53
  v_cvt_pk_bf16_f32 v51, v54, v55
  v_cvt_pk_bf16_f32 v52, v56, v57
  ds_read_b128 v[132:135], v148 offset:43072
  s_waitcnt lgkmcnt(2)
  v_mfma_f32_32x32x16_bf16 v[64:79], a[100:103], v[136:139], v[64:79]
  v_cvt_pk_bf16_f32 v53, v58, v59
  v_cvt_pk_bf16_f32 v54, v60, v61
  v_cvt_pk_bf16_f32 v55, v62, v63
  buffer_store_dwordx4 v[48:51], v2, s[40:43], s73 offen offset:0 sc1
  ds_read_b128 v[136:139], v148 offset:44096
  s_waitcnt lgkmcnt(2)
  v_mfma_f32_32x32x16_bf16 v[64:79], a[108:111], v[140:143], v[64:79]
  buffer_store_dwordx4 v[52:55], v2, s[40:43], s73 offen offset:1024 sc1
  ds_read_b128 v[140:143], v148 offset:45120
  s_waitcnt lgkmcnt(2)
  v_mfma_f32_32x32x16_bf16 v[64:79], a[116:119], v[132:135], v[64:79]
  ds_read_b128 v[132:135], v148 offset:46144
  s_waitcnt lgkmcnt(2)
  v_mfma_f32_32x32x16_bf16 v[64:79], a[124:127], v[136:139], v[64:79]
  ds_read_b128 v[136:139], v148 offset:47168
  s_waitcnt lgkmcnt(2)
  v_mfma_f32_32x32x16_bf16 v[64:79], a[132:135], v[140:143], v[64:79]
  ds_read_b128 v[140:143], v148 offset:48192
  s_waitcnt lgkmcnt(2)
  v_mfma_f32_32x32x16_bf16 v[64:79], a[140:143], v[132:135], v[64:79]
  ds_read_b128 v[132:135], v148 offset:49216
  s_waitcnt lgkmcnt(2)
  v_mfma_f32_32x32x16_bf16 v[64:79], a[148:151], v[136:139], v[64:79]
  ds_read_b128 v[136:139], v148 offset:50240
  s_waitcnt lgkmcnt(2)
  v_mfma_f32_32x32x16_bf16 v[64:79], a[156:159], v[140:143], v[64:79]
  ds_read_b128 v[140:143], v148 offset:51264
  s_waitcnt lgkmcnt(2)
  v_mfma_f32_32x32x16_bf16 v[64:79], a[164:167], v[132:135], v[64:79]
  ds_read_b128 v[132:135], v148 offset:52288
  s_waitcnt lgkmcnt(2)
  v_mfma_f32_32x32x16_bf16 v[64:79], a[172:175], v[136:139], v[64:79]
  ds_read_b128 v[136:139], v148 offset:53312
  s_waitcnt lgkmcnt(2)
  v_mfma_f32_32x32x16_bf16 v[64:79], a[180:183], v[140:143], v[64:79]
  ds_read_b128 v[140:143], v148 offset:54336
  s_waitcnt lgkmcnt(2)
  v_mfma_f32_32x32x16_bf16 v[64:79], a[188:191], v[132:135], v[64:79]
  ds_read_b128 v[132:135], v148 offset:55360
  s_waitcnt lgkmcnt(2)
  v_mfma_f32_32x32x16_bf16 v[64:79], a[196:199], v[136:139], v[64:79]
  ds_read_b128 v[136:139], v148 offset:56384
  s_waitcnt lgkmcnt(2)
  v_mfma_f32_32x32x16_bf16 v[64:79], a[204:207], v[140:143], v[64:79]
  s_waitcnt lgkmcnt(1)
  v_mfma_f32_32x32x16_bf16 v[64:79], a[212:215], v[132:135], v[64:79]
  s_waitcnt lgkmcnt(0)
  v_mfma_f32_32x32x16_bf16 v[64:79], a[220:223], v[136:139], v[64:79]
  s_add_u32 s73, s75, 25280512
  ds_read_b128 v[108:111], v151 offset:128
  ds_read_b128 v[112:115], v151 offset:144
  s_waitcnt lgkmcnt(0)
  s_nop 7
  v_fmac_f32 v64, v108, v158
  v_fmac_f32 v65, v109, v158
  v_fmac_f32 v66, v110, v158
  v_fmac_f32 v67, v111, v158
  v_fmac_f32 v68, v112, v158
  v_fmac_f32 v69, v113, v158
  v_fmac_f32 v70, v114, v158
  v_fmac_f32 v71, v115, v158
  ds_read_b128 v[108:111], v151 offset:160
  ds_read_b128 v[112:115], v151 offset:176
  s_waitcnt lgkmcnt(0)
  v_fmac_f32 v72, v108, v158
  v_fmac_f32 v73, v109, v158
  v_fmac_f32 v74, v110, v158
  v_fmac_f32 v75, v111, v158
  v_fmac_f32 v76, v112, v158
  v_fmac_f32 v77, v113, v158
  v_fmac_f32 v78, v114, v158
  v_fmac_f32 v79, v115, v158
  v_cvt_pk_bf16_f32 v64, v64, v65
  v_cvt_pk_bf16_f32 v65, v66, v67
  v_cvt_pk_bf16_f32 v66, v68, v69
  v_cvt_pk_bf16_f32 v67, v70, v71
  v_cvt_pk_bf16_f32 v68, v72, v73
  v_cvt_pk_bf16_f32 v69, v74, v75
  v_cvt_pk_bf16_f32 v70, v76, v77
  v_cvt_pk_bf16_f32 v71, v78, v79
  v_pk_max_i16 v64, v64, 0
  v_pk_max_i16 v65, v65, 0
  v_pk_max_i16 v66, v66, 0
  v_pk_max_i16 v67, v67, 0
  v_pk_max_i16 v68, v68, 0
  v_pk_max_i16 v69, v69, 0
  v_pk_max_i16 v70, v70, 0
  v_pk_max_i16 v71, v71, 0
  buffer_store_dwordx4 v[64:67], v2, s[40:43], s73 offen offset:2048 sc1
  buffer_store_dwordx4 v[68:71], v2, s[40:43], s73 offen offset:3072 sc1
  s_waitcnt vmcnt(4)
PH10:
  v_xor_b32 v126, s66, v126
  v_xor_b32 v127, s67, v127
  v_or_b32 v126, v126, v127
  v_cmp_ne_u32 vcc, 0, v126
  s_nop 0
  s_cbranch_vccz PH10_D
  s_add_u32 s83, s83, 1
  s_cmp_gt_u32 s83, 0x40000
  s_cbranch_scc1 PH10_D
  s_sleep 4
  buffer_load_dwordx2 v[126:127], v145, s[40:43], s82 offen sc1
  s_waitcnt vmcnt(0)
  s_branch PH10
PH10_D:
  s_add_u32 s70, s77, 25165824
  buffer_load_dwordx4 v[96:99], v2, s[40:43], s70 offen offset:0 sc1
  s_add_u32 s70, s77, 25165824
  buffer_load_dwordx4 v[100:103], v2, s[40:43], s70 offen offset:1024 sc1
  s_add_u32 s70, s77, 25165824
  buffer_load_dwordx4 v[104:107], v2, s[40:43], s70 offen offset:2048 sc1
  s_add_u32 s70, s77, 25165824
  buffer_load_dwordx4 v[108:111], v2, s[40:43], s70 offen offset:3072 sc1
  s_add_u32 s70, s77, 25169920
  buffer_load_dwordx4 v[112:115], v2, s[40:43], s70 offen offset:0 sc1
  s_add_u32 s70, s77, 25169920
  buffer_load_dwordx4 v[116:119], v2, s[40:43], s70 offen offset:1024 sc1
  s_add_u32 s70, s77, 25169920
  buffer_load_dwordx4 v[120:123], v2, s[40:43], s70 offen offset:2048 sc1
  s_add_u32 s70, s77, 25169920
  buffer_load_dwordx4 v[80:83], v2, s[40:43], s70 offen offset:3072 sc1
  s_add_u32 s70, s77, 25174016
  buffer_load_dwordx4 v[84:87], v2, s[40:43], s70 offen offset:0 sc1
  s_add_u32 s70, s77, 25174016
  buffer_load_dwordx4 v[88:91], v2, s[40:43], s70 offen offset:1024 sc1
  s_add_u32 s70, s77, 25174016
  buffer_load_dwordx4 v[92:95], v2, s[40:43], s70 offen offset:2048 sc1
  s_add_u32 s70, s77, 25174016
  buffer_load_dwordx4 v[140:143], v2, s[40:43], s70 offen offset:3072 sc1
  s_waitcnt vmcnt(11)
  v_mfma_f32_32x32x16_bf16 v[16:31], a[224:227], v[96:99], 0
  s_add_u32 s81, s76, 40960
  s_mov_b64 exec, 1
  buffer_store_dwordx2 v[4:5], v0, s[40:43], s81 offen sc1
  s_mov_b64 exec, -1
  v_mfma_f32_32x32x16_bf16 v[32:47], a[228:231], v[96:99], 0
  s_add_u32 s70, s77, 25178112
  buffer_load_dwordx4 v[96:99], v2, s[40:43], s70 offen offset:0 sc1
  s_waitcnt vmcnt(12)
  v_mfma_f32_32x32x16_bf16 v[16:31], a[232:235], v[100:103], v[16:31]
  v_mfma_f32_32x32x16_bf16 v[32:47], a[236:239], v[100:103], v[32:47]
  s_add_u32 s70, s77, 25178112
  buffer_load_dwordx4 v[100:103], v2, s[40:43], s70 offen offset:1024 sc1
  s_waitcnt vmcnt(12)
  v_mfma_f32_32x32x16_bf16 v[16:31], a[240:243], v[104:107], v[16:31]
  v_mfma_f32_32x32x16_bf16 v[32:47], a[244:247], v[104:107], v[32:47]
  s_add_u32 s70, s77, 25178112
  buffer_load_dwordx4 v[104:107], v2, s[40:43], s70 offen offset:2048 sc1
  s_waitcnt vmcnt(12)
  v_mfma_f32_32x32x16_bf16 v[16:31], a[248:251], v[108:111], v[16:31]
  v_mfma_f32_32x32x16_bf16 v[32:47], a[252:255], v[108:111], v[32:47]
  s_add_u32 s70, s77, 25178112
  buffer_load_dwordx4 v[108:111], v2, s[40:43], s70 offen offset:3072 sc1
  s_waitcnt vmcnt(12)
  v_mfma_f32_32x32x16_bf16 v[16:31], v[160:163], v[112:115], v[16:31]
  v_mfma_f32_32x32x16_bf16 v[32:47], v[164:167], v[112:115], v[32:47]
  s_add_u32 s70, s77, 25182208
  buffer_load_dwordx4 v[112:115], v2, s[40:43], s70 offen offset:0 sc1
  s_waitcnt vmcnt(12)
  v_mfma_f32_32x32x16_bf16 v[16:31], v[168:171], v[116:119], v[16:31]
  v_mfma_f32_32x32x16_bf16 v[32:47], v[172:175], v[116:119], v[32:47]
  s_add_u32 s70, s77, 25182208
  buffer_load_dwordx4 v[116:119], v2, s[40:43], s70 offen offset:1024 sc1
  s_waitcnt vmcnt(12)
  v_mfma_f32_32x32x16_bf16 v[16:31], v[176:179], v[120:123], v[16:31]
  v_mfma_f32_32x32x16_bf16 v[32:47], v[180:183], v[120:123], v[32:47]
  s_add_u32 s70, s77, 25182208
  buffer_load_dwordx4 v[120:123], v2, s[40:43], s70 offen offset:2048 sc1
  s_waitcnt vmcnt(12)
  v_mfma_f32_32x32x16_bf16 v[16:31], v[184:187], v[80:83], v[16:31]
  v_mfma_f32_32x32x16_bf16 v[32:47], v[188:191], v[80:83], v[32:47]
  s_add_u32 s70, s77, 25182208
  buffer_load_dwordx4 v[80:83], v2, s[40:43], s70 offen offset:3072 sc1
  s_waitcnt vmcnt(12)
  v_mfma_f32_32x32x16_bf16 v[16:31], v[192:195], v[84:87], v[16:31]
  v_mfma_f32_32x32x16_bf16 v[32:47], v[196:199], v[84:87], v[32:47]
  s_add_u32 s70, s77, 25186304
  buffer_load_dwordx4 v[84:87], v2, s[40:43], s70 offen offset:0 sc1
  s_waitcnt vmcnt(12)
  v_mfma_f32_32x32x16_bf16 v[16:31], v[200:203], v[88:91], v[16:31]
  v_mfma_f32_32x32x16_bf16 v[32:47], v[204:207], v[88:91], v[32:47]
  s_add_u32 s70, s77, 25186304
  buffer_load_dwordx4 v[88:91], v2, s[40:43], s70 offen offset:1024 sc1
  s_waitcnt vmcnt(12)
  v_mfma_f32_32x32x16_bf16 v[16:31], v[208:211], v[92:95], v[16:31]
  v_mfma_f32_32x32x16_bf16 v[32:47], v[212:215], v[92:95], v[32:47]
  s_add_u32 s70, s77, 25186304
  buffer_load_dwordx4 v[92:95], v2, s[40:43], s70 offen offset:2048 sc1
  s_waitcnt vmcnt(12)
  v_mfma_f32_32x32x16_bf16 v[16:31], v[216:219], v[140:143], v[16:31]
  v_mfma_f32_32x32x16_bf16 v[32:47], v[220:223], v[140:143], v[32:47]
  s_add_u32 s70, s77, 25186304
  buffer_load_dwordx4 v[140:143], v2, s[40:43], s70 offen offset:3072 sc1
  s_waitcnt vmcnt(11)
  v_mfma_f32_32x32x16_bf16 v[16:31], v[224:227], v[96:99], v[16:31]
  v_mfma_f32_32x32x16_bf16 v[32:47], v[228:231], v[96:99], v[32:47]
  s_add_u32 s70, s77, 25190400
  buffer_load_dwordx4 v[96:99], v2, s[40:43], s70 offen offset:0 sc1
  s_waitcnt vmcnt(11)
  v_mfma_f32_32x32x16_bf16 v[16:31], v[232:235], v[100:103], v[16:31]
  v_mfma_f32_32x32x16_bf16 v[32:47], v[236:239], v[100:103], v[32:47]
  s_add_u32 s70, s77, 25190400
  buffer_load_dwordx4 v[100:103], v2, s[40:43], s70 offen offset:1024 sc1
  ds_read_b128 v[124:127], v152 offset:0
  ds_read_b128 v[128:131], v152 offset:1024
  s_waitcnt vmcnt(11)
  v_mfma_f32_32x32x16_bf16 v[16:31], v[240:243], v[104:107], v[16:31]
  v_mfma_f32_32x32x16_bf16 v[32:47], v[244:247], v[104:107], v[32:47]
  s_add_u32 s70, s77, 25190400
  buffer_load_dwordx4 v[104:107], v2, s[40:43], s70 offen offset:2048 sc1
  ds_read_b128 v[132:135], v152 offset:8192
  ds_read_b128 v[136:139], v152 offset:9216
  s_waitcnt vmcnt(11)
  v_mfma_f32_32x32x16_bf16 v[16:31], v[248:251], v[108:111], v[16:31]
  v_mfma_f32_32x32x16_bf16 v[32:47], v[252:255], v[108:111], v[32:47]
  s_add_u32 s70, s77, 25190400
  buffer_load_dwordx4 v[108:111], v2, s[40:43], s70 offen offset:3072 sc1
  s_waitcnt vmcnt(11) lgkmcnt(2)
  v_mfma_f32_32x32x16_bf16 v[16:31], v[124:127], v[112:115], v[16:31]
  v_mfma_f32_32x32x16_bf16 v[32:47], v[128:131], v[112:115], v[32:47]
  ds_read_b128 v[124:127], v152 offset:16384
  ds_read_b128 v[128:131], v152 offset:17408
  s_waitcnt vmcnt(10) lgkmcnt(2)
  v_mfma_f32_32x32x16_bf16 v[16:31], v[132:135], v[116:119], v[16:31]
  v_mfma_f32_32x32x16_bf16 v[32:47], v[136:139], v[116:119], v[32:47]
  ds_read_b128 v[132:135], v152 offset:24576
  ds_read_b128 v[136:139], v152 offset:25600
  s_waitcnt vmcnt(9) lgkmcnt(2)
  v_mfma_f32_32x32x16_bf16 v[16:31], v[124:127], v[120:123], v[16:31]
  s_add_u32 s82, s69, 40960
  buffer_load_dwordx2 v[76:77], v145, s[40:43], s82 offen sc1
  v_mfma_f32_32x32x16_bf16 v[32:47], v[128:131], v[120:123], v[32:47]
  ds_read_b128 v[124:127], v152 offset:32768
  ds_read_b128 v[128:131], v152 offset:33792
  s_waitcnt vmcnt(9) lgkmcnt(2)
  v_mfma_f32_32x32x16_bf16 v[16:31], v[132:135], v[80:83], v[16:31]
  v_mfma_f32_32x32x16_bf16 v[32:47], v[136:139], v[80:83], v[32:47]
  ds_read_b128 v[132:135], v152 offset:40960
  ds_read_b128 v[136:139], v152 offset:41984
  s_waitcnt vmcnt(8) lgkmcnt(2)
  v_mfma_f32_32x32x16_bf16 v[16:31], v[124:127], v[84:87], v[16:31]
  v_mfma_f32_32x32x16_bf16 v[32:47], v[128:131], v[84:87], v[32:47]
  ds_read_b128 v[124:127], v152 offset:49152
  ds_read_b128 v[128:131], v152 offset:50176
  s_waitcnt vmcnt(7) lgkmcnt(2)
  v_mfma_f32_32x32x16_bf16 v[16:31], v[132:135], v[88:91], v[16:31]
  v_mfma_f32_32x32x16_bf16 v[32:47], v[136:139], v[88:91], v[32:47]
  ds_read_b128 v[132:135], v152 offset:57344
  ds_read_b128 v[136:139], v152 offset:58368
  s_waitcnt vmcnt(6) lgkmcnt(2)
  v_mfma_f32_32x32x16_bf16 v[16:31], v[124:127], v[92:95], v[16:31]
  v_mfma_f32_32x32x16_bf16 v[32:47], v[128:131], v[92:95], v[32:47]
  v_add_u32 v152, 0x10000, v152
  ds_read_b128 v[124:127], v152 offset:0
  ds_read_b128 v[128:131], v152 offset:1024
  s_waitcnt vmcnt(5) lgkmcnt(2)
  v_mfma_f32_32x32x16_bf16 v[16:31], v[132:135], v[140:143], v[16:31]
  v_mfma_f32_32x32x16_bf16 v[32:47], v[136:139], v[140:143], v[32:47]
  ds_read_b128 v[132:135], v152 offset:8192
  ds_read_b128 v[136:139], v152 offset:9216
  s_waitcnt vmcnt(4) lgkmcnt(2)
  v_mfma_f32_32x32x16_bf16 v[16:31], v[124:127], v[96:99], v[16:31]
  v_mfma_f32_32x32x16_bf16 v[32:47], v[128:131], v[96:99], v[32:47]
  ds_read_b128 v[124:127], v152 offset:16384
  ds_read_b128 v[128:131], v152 offset:17408
  s_waitcnt vmcnt(3) lgkmcnt(2)
  v_mfma_f32_32x32x16_bf16 v[16:31], v[132:135], v[100:103], v[16:31]
  v_mfma_f32_32x32x16_bf16 v[32:47], v[136:139], v[100:103], v[32:47]
  ds_read_b128 v[132:135], v152 offset:24576
  ds_read_b128 v[136:139], v152 offset:25600
  s_waitcnt vmcnt(2) lgkmcnt(2)
  v_mfma_f32_32x32x16_bf16 v[16:31], v[124:127], v[104:107], v[16:31]
  v_mfma_f32_32x32x16_bf16 v[32:47], v[128:131], v[104:107], v[32:47]
  s_waitcnt vmcnt(1) lgkmcnt(0)
  v_mfma_f32_32x32x16_bf16 v[16:31], v[132:135], v[108:111], v[16:31]
  v_mfma_f32_32x32x16_bf16 v[32:47], v[136:139], v[108:111], v[32:47]
  v_subrev_u32 v152, 0x10000, v152
  s_cmp_lg_u32 s3, 0
  s_cbranch_scc1 E2_10_R1
  s_nop 7
  ds_write_b128 v148, v[24:27] offset:10240
  ds_write_b128 v148, v[28:31] offset:11264
  ds_write_b128 v148, v[32:35] offset:14336
  ds_write_b128 v148, v[36:39] offset:15360
  ds_write_b128 v148, v[40:43] offset:18432
  ds_write_b128 v148, v[44:47] offset:19456
  s_branch E2_10_RD
E2_10_R1:
  s_cmp_lg_u32 s3, 1
  s_cbranch_scc1 E2_10_R2
  s_nop 5
  ds_write_b128 v148, v[16:19] offset:0
  ds_write_b128 v148, v[20:23] offset:1024
  ds_write_b128 v148, v[32:35] offset:16384
  ds_write_b128 v148, v[36:39] offset:17408
  ds_write_b128 v148, v[40:43] offset:20480
  ds_write_b128 v148, v[44:47] offset:21504
  v_mov_b32 v16, v24
  v_mov_b32 v17, v25
  v_mov_b32 v18, v26
  v_mov_b32 v19, v27
  v_mov_b32 v20, v28
  v_mov_b32 v21, v29
  v_mov_b32 v22, v30
  v_mov_b32 v23, v31
  s_branch E2_10_RD
E2_10_R2:
  s_cmp_lg_u32 s3, 2
  s_cbranch_scc1 E2_10_R3
  s_nop 3
  ds_write_b128 v148, v[16:19] offset:2048
  ds_write_b128 v148, v[20:23] offset:3072
  ds_write_b128 v148, v[24:27] offset:6144
  ds_write_b128 v148, v[28:31] offset:7168
  ds_write_b128 v148, v[40:43] offset:22528
  ds_write_b128 v148, v[44:47] offset:23552
  v_mov_b32 v16, v32
  v_mov_b32 v17, v33
  v_mov_b32 v18, v34
  v_mov_b32 v19, v35
  v_mov_b32 v20, v36
  v_mov_b32 v21, v37
  v_mov_b32 v22, v38
  v_mov_b32 v23, v39
  s_branch E2_10_RD
E2_10_R3:
  s_nop 3
  ds_write_b128 v148, v[16:19] offset:4096
  ds_write_b128 v148, v[20:23] offset:5120
  ds_write_b128 v148, v[24:27] offset:8192
  ds_write_b128 v148, v[28:31] offset:9216
  ds_write_b128 v148, v[32:35] offset:12288
  ds_write_b128 v148, v[36:39] offset:13312
  v_mov_b32 v16, v40
  v_mov_b32 v17, v41
  v_mov_b32 v18, v42
  v_mov_b32 v19, v43
  v_mov_b32 v20, v44
  v_mov_b32 v21, v45
  v_mov_b32 v22, v46
  v_mov_b32 v23, v47
E2_10_RD:
  s_waitcnt vmcnt(0)
PH11:
  v_xor_b32 v76, s66, v76
  v_xor_b32 v77, s67, v77
  v_or_b32 v76, v76, v77
  v_cmp_ne_u32 vcc, 0, v76
  s_nop 0
  s_cbranch_vccz PH11_D
  s_add_u32 s83, s83, 1
  s_cmp_gt_u32 s83, 0x40000
  s_cbranch_scc1 PH11_D
  s_sleep 4
  buffer_load_dwordx2 v[76:77], v145, s[40:43], s82 offen sc1
  s_waitcnt vmcnt(0)
  s_branch PH11
PH11_D:
  s_add_u32 s70, s77, 25280512
  buffer_load_dwordx4 v[112:115], v2, s[40:43], s70 offen offset:0 sc1
  s_add_u32 s70, s77, 25280512
  buffer_load_dwordx4 v[116:119], v2, s[40:43], s70 offen offset:1024 sc1
  s_add_u32 s70, s77, 25280512
  buffer_load_dwordx4 v[120:123], v2, s[40:43], s70 offen offset:2048 sc1
  s_add_u32 s70, s77, 25280512
  buffer_load_dwordx4 v[80:83], v2, s[40:43], s70 offen offset:3072 sc1
  s_add_u32 s70, s77, 25284608
  buffer_load_dwordx4 v[84:87], v2, s[40:43], s70 offen offset:0 sc1
  s_add_u32 s70, s77, 25284608
  buffer_load_dwordx4 v[88:91], v2, s[40:43], s70 offen offset:1024 sc1
  s_add_u32 s70, s77, 25284608
  buffer_load_dwordx4 v[92:95], v2, s[40:43], s70 offen offset:2048 sc1
  s_add_u32 s70, s77, 25284608
  buffer_load_dwordx4 v[140:143], v2, s[40:43], s70 offen offset:3072 sc1
  s_add_u32 s70, s77, 25288704
  buffer_load_dwordx4 v[96:99], v2, s[40:43], s70 offen offset:0 sc1
  s_add_u32 s70, s77, 25288704
  buffer_load_dwordx4 v[100:103], v2, s[40:43], s70 offen offset:1024 sc1
  s_add_u32 s70, s77, 25288704
  buffer_load_dwordx4 v[104:107], v2, s[40:43], s70 offen offset:2048 sc1
  s_add_u32 s70, s77, 25288704
  buffer_load_dwordx4 v[108:111], v2, s[40:43], s70 offen offset:3072 sc1
  s_waitcnt lgkmcnt(0)
  s_barrier
  ds_read_b128 v[24:27], v153 offset:0
  ds_read_b128 v[28:31], v153 offset:1024
  ds_read_b128 v[32:35], v153 offset:2048
  ds_read_b128 v[36:39], v153 offset:3072
  ds_read_b128 v[40:43], v153 offset:4096
  ds_read_b128 v[44:47], v153 offset:5120
  s_waitcnt lgkmcnt(4)
  v_pk_add_f32 v[16:17], v[16:17], v[24:25]
  v_pk_add_f32 v[18:19], v[18:19], v[26:27]
  v_pk_add_f32 v[20:21], v[20:21], v[28:29]
  v_pk_add_f32 v[22:23], v[22:23], v[30:31]
  s_waitcnt lgkmcnt(2)
  v_pk_add_f32 v[16:17], v[16:17], v[32:33]
  v_pk_add_f32 v[18:19], v[18:19], v[34:35]
  v_pk_add_f32 v[20:21], v[20:21], v[36:37]
  v_pk_add_f32 v[22:23], v[22:23], v[38:39]
  s_waitcnt lgkmcnt(0)
  v_pk_add_f32 v[16:17], v[16:17], v[40:41]
  v_pk_add_f32 v[18:19], v[18:19], v[42:43]
  v_pk_add_f32 v[20:21], v[20:21], v[44:45]
  v_pk_add_f32 v[22:23], v[22:23], v[46:47]
  v_mul_f32 v16, v16, v157
  v_mul_f32 v17, v17, v157
  v_mul_f32 v18, v18, v157
  v_mul_f32 v19, v19, v157
  v_mul_f32 v20, v20, v157
  v_mul_f32 v21, v21, v157
  v_mul_f32 v22, v22, v157
  v_mul_f32 v23, v23, v157
  v_cvt_pk_bf16_f32 v24, v16, v17
  v_cvt_pk_bf16_f32 v25, v18, v19
  v_cvt_pk_bf16_f32 v26, v20, v21
  v_cvt_pk_bf16_f32 v27, v22, v23
  s_nop 0
  v_permlane32_swap_b32 v24, v26
  v_permlane32_swap_b32 v25, v27
  v_lshlrev_b32 v16, 16, v24
  v_and_b32 v17, s64, v24
  v_lshlrev_b32 v18, 16, v25
  v_and_b32 v19, s64, v25
  v_lshlrev_b32 v20, 16, v26
  v_and_b32 v21, s64, v26
  v_lshlrev_b32 v22, 16, v27
  v_and_b32 v23, s64, v27
  v_dot2_f32_bf16 v16, v8, s60, v16
  v_dot2_f32_bf16 v17, v8, s61, v17
  v_dot2_f32_bf16 v18, v9, s60, v18
  v_dot2_f32_bf16 v19, v9, s61, v19
  v_dot2_f32_bf16 v20, v10, s60, v20
  v_dot2_f32_bf16 v21, v10, s61, v21
  v_dot2_f32_bf16 v22, v11, s60, v22
  v_dot2_f32_bf16 v23, v11, s61, v23
  v_cvt_pk_bf16_f32 v44, v16, v17
  v_cvt_pk_bf16_f32 v45, v18, v19
  v_cvt_pk_bf16_f32 v46, v20, v21
  v_cvt_pk_bf16_f32 v47, v22, v23
  s_add_u32 s73, s79, 0
  buffer_store_dwordx4 v[44:47], v155, s[52:55], s73 offen
  s_waitcnt vmcnt(12)
  v_mfma_f32_32x32x16_bf16 v[48:63], a[224:227], v[112:115], 0
  v_mfma_f32_32x32x16_bf16 v[64:79], a[228:231], v[112:115], 0
  s_add_u32 s70, s77, 25292800
  buffer_load_dwordx4 v[112:115], v2, s[40:43], s70 offen offset:0 sc1
  s_waitcnt vmcnt(12)
  v_mfma_f32_32x32x16_bf16 v[48:63], a[232:235], v[116:119], v[48:63]
  v_mfma_f32_32x32x16_bf16 v[64:79], a[236:239], v[116:119], v[64:79]
  s_add_u32 s70, s77, 25292800
  buffer_load_dwordx4 v[116:119], v2, s[40:43], s70 offen offset:1024 sc1
  s_waitcnt vmcnt(12)
  v_mfma_f32_32x32x16_bf16 v[48:63], a[240:243], v[120:123], v[48:63]
  v_mfma_f32_32x32x16_bf16 v[64:79], a[244:247], v[120:123], v[64:79]
  s_add_u32 s70, s77, 25292800
  buffer_load_dwordx4 v[120:123], v2, s[40:43], s70 offen offset:2048 sc1
  s_waitcnt vmcnt(12)
  v_mfma_f32_32x32x16_bf16 v[48:63], a[248:251], v[80:83], v[48:63]
  v_mfma_f32_32x32x16_bf16 v[64:79], a[252:255], v[80:83], v[64:79]
  s_add_u32 s70, s77, 25292800
  buffer_load_dwordx4 v[80:83], v2, s[40:43], s70 offen offset:3072 sc1
  s_waitcnt vmcnt(12)
  v_mfma_f32_32x32x16_bf16 v[48:63], v[160:163], v[84:87], v[48:63]
  v_mfma_f32_32x32x16_bf16 v[64:79], v[164:167], v[84:87], v[64:79]
  s_add_u32 s70, s77, 25296896
  buffer_load_dwordx4 v[84:87], v2, s[40:43], s70 offen offset:0 sc1
  s_waitcnt vmcnt(12)
  v_mfma_f32_32x32x16_bf16 v[48:63], v[168:171], v[88:91], v[48:63]
  v_mfma_f32_32x32x16_bf16 v[64:79], v[172:175], v[88:91], v[64:79]
  s_add_u32 s70, s77, 25296896
  buffer_load_dwordx4 v[88:91], v2, s[40:43], s70 offen offset:1024 sc1
  s_waitcnt vmcnt(12)
  v_mfma_f32_32x32x16_bf16 v[48:63], v[176:179], v[92:95], v[48:63]
  v_mfma_f32_32x32x16_bf16 v[64:79], v[180:183], v[92:95], v[64:79]
  s_add_u32 s70, s77, 25296896
  buffer_load_dwordx4 v[92:95], v2, s[40:43], s70 offen offset:2048 sc1
  s_waitcnt vmcnt(12)
  v_mfma_f32_32x32x16_bf16 v[48:63], v[184:187], v[140:143], v[48:63]
  v_mfma_f32_32x32x16_bf16 v[64:79], v[188:191], v[140:143], v[64:79]
  s_add_u32 s70, s77, 25296896
  buffer_load_dwordx4 v[140:143], v2, s[40:43], s70 offen offset:3072 sc1
  s_waitcnt vmcnt(12)
  v_mfma_f32_32x32x16_bf16 v[48:63], v[192:195], v[96:99], v[48:63]
  v_mfma_f32_32x32x16_bf16 v[64:79], v[196:199], v[96:99], v[64:79]
  s_add_u32 s70, s77, 25300992
  buffer_load_dwordx4 v[96:99], v2, s[40:43], s70 offen offset:0 sc1
  s_waitcnt vmcnt(12)
  v_mfma_f32_32x32x16_bf16 v[48:63], v[200:203], v[100:103], v[48:63]
  v_mfma_f32_32x32x16_bf16 v[64:79], v[204:207], v[100:103], v[64:79]
  s_add_u32 s70, s77, 25300992
  buffer_load_dwordx4 v[100:103], v2, s[40:43], s70 offen offset:1024 sc1
  s_waitcnt vmcnt(12)
  v_mfma_f32_32x32x16_bf16 v[48:63], v[208:211], v[104:107], v[48:63]
  v_mfma_f32_32x32x16_bf16 v[64:79], v[212:215], v[104:107], v[64:79]
  s_add_u32 s70, s77, 25300992
  buffer_load_dwordx4 v[104:107], v2, s[40:43], s70 offen offset:2048 sc1
  s_waitcnt vmcnt(12)
  v_mfma_f32_32x32x16_bf16 v[48:63], v[216:219], v[108:111], v[48:63]
  v_mfma_f32_32x32x16_bf16 v[64:79], v[220:223], v[108:111], v[64:79]
  s_add_u32 s70, s77, 25300992
  buffer_load_dwordx4 v[108:111], v2, s[40:43], s70 offen offset:3072 sc1
  s_waitcnt vmcnt(11)
  v_mfma_f32_32x32x16_bf16 v[48:63], v[224:227], v[112:115], v[48:63]
  v_mfma_f32_32x32x16_bf16 v[64:79], v[228:231], v[112:115], v[64:79]
  s_add_u32 s70, s77, 25305088
  buffer_load_dwordx4 v[112:115], v2, s[40:43], s70 offen offset:0 sc1
  s_waitcnt vmcnt(11)
  v_mfma_f32_32x32x16_bf16 v[48:63], v[232:235], v[116:119], v[48:63]
  v_mfma_f32_32x32x16_bf16 v[64:79], v[236:239], v[116:119], v[64:79]
  s_add_u32 s70, s77, 25305088
  buffer_load_dwordx4 v[116:119], v2, s[40:43], s70 offen offset:1024 sc1
  ds_read_b128 v[124:127], v152 offset:0
  ds_read_b128 v[128:131], v152 offset:1024
  s_waitcnt vmcnt(11)
  v_mfma_f32_32x32x16_bf16 v[48:63], v[240:243], v[120:123], v[48:63]
  v_mfma_f32_32x32x16_bf16 v[64:79], v[244:247], v[120:123], v[64:79]
  s_add_u32 s70, s77, 25305088
  buffer_load_dwordx4 v[120:123], v2, s[40:43], s70 offen offset:2048 sc1
  ds_read_b128 v[132:135], v152 offset:8192
  ds_read_b128 v[136:139], v152 offset:9216
  s_waitcnt vmcnt(11)
  v_mfma_f32_32x32x16_bf16 v[48:63], v[248:251], v[80:83], v[48:63]
  v_mfma_f32_32x32x16_bf16 v[64:79], v[252:255], v[80:83], v[64:79]
  s_add_u32 s70, s77, 25305088
  buffer_load_dwordx4 v[80:83], v2, s[40:43], s70 offen offset:3072 sc1
  s_waitcnt vmcnt(11) lgkmcnt(2)
  v_mfma_f32_32x32x16_bf16 v[48:63], v[124:127], v[84:87], v[48:63]
  v_mfma_f32_32x32x16_bf16 v[64:79], v[128:131], v[84:87], v[64:79]
  ds_read_b128 v[124:127], v152 offset:16384
  ds_read_b128 v[128:131], v152 offset:17408
  s_waitcnt vmcnt(10) lgkmcnt(2)
  v_mfma_f32_32x32x16_bf16 v[48:63], v[132:135], v[88:91], v[48:63]
  v_mfma_f32_32x32x16_bf16 v[64:79], v[136:139], v[88:91], v[64:79]
  ds_read_b128 v[132:135], v152 offset:24576
  ds_read_b128 v[136:139], v152 offset:25600
  s_waitcnt vmcnt(9) lgkmcnt(2)
  v_mfma_f32_32x32x16_bf16 v[48:63], v[124:127], v[92:95], v[48:63]
  v_mfma_f32_32x32x16_bf16 v[64:79], v[128:131], v[92:95], v[64:79]
  ds_read_b128 v[124:127], v152 offset:32768
  ds_read_b128 v[128:131], v152 offset:33792
  s_waitcnt vmcnt(8) lgkmcnt(2)
  v_mfma_f32_32x32x16_bf16 v[48:63], v[132:135], v[140:143], v[48:63]
  v_mfma_f32_32x32x16_bf16 v[64:79], v[136:139], v[140:143], v[64:79]
  ds_read_b128 v[132:135], v152 offset:40960
  ds_read_b128 v[136:139], v152 offset:41984
  s_waitcnt vmcnt(7) lgkmcnt(2)
  v_mfma_f32_32x32x16_bf16 v[48:63], v[124:127], v[96:99], v[48:63]
  v_mfma_f32_32x32x16_bf16 v[64:79], v[128:131], v[96:99], v[64:79]
  ds_read_b128 v[124:127], v152 offset:49152
  ds_read_b128 v[128:131], v152 offset:50176
  s_waitcnt vmcnt(6) lgkmcnt(2)
  v_mfma_f32_32x32x16_bf16 v[48:63], v[132:135], v[100:103], v[48:63]
  v_mfma_f32_32x32x16_bf16 v[64:79], v[136:139], v[100:103], v[64:79]
  ds_read_b128 v[132:135], v152 offset:57344
  ds_read_b128 v[136:139], v152 offset:58368
  s_waitcnt vmcnt(5) lgkmcnt(2)
  v_mfma_f32_32x32x16_bf16 v[48:63], v[124:127], v[104:107], v[48:63]
  v_mfma_f32_32x32x16_bf16 v[64:79], v[128:131], v[104:107], v[64:79]
  v_add_u32 v152, 0x10000, v152
  ds_read_b128 v[124:127], v152 offset:0
  ds_read_b128 v[128:131], v152 offset:1024
  s_waitcnt vmcnt(4) lgkmcnt(2)
  v_mfma_f32_32x32x16_bf16 v[48:63], v[132:135], v[108:111], v[48:63]
  v_mfma_f32_32x32x16_bf16 v[64:79], v[136:139], v[108:111], v[64:79]
  ds_read_b128 v[132:135], v152 offset:8192
  ds_read_b128 v[136:139], v152 offset:9216
  s_waitcnt vmcnt(3) lgkmcnt(2)
  v_mfma_f32_32x32x16_bf16 v[48:63], v[124:127], v[112:115], v[48:63]
  v_mfma_f32_32x32x16_bf16 v[64:79], v[128:131], v[112:115], v[64:79]
  ds_read_b128 v[124:127], v152 offset:16384
  ds_read_b128 v[128:131], v152 offset:17408
  s_waitcnt vmcnt(2) lgkmcnt(2)
  v_mfma_f32_32x32x16_bf16 v[48:63], v[132:135], v[116:119], v[48:63]
  v_mfma_f32_32x32x16_bf16 v[64:79], v[136:139], v[116:119], v[64:79]
  ds_read_b128 v[132:135], v152 offset:24576
  ds_read_b128 v[136:139], v152 offset:25600
  s_waitcnt vmcnt(1) lgkmcnt(2)
  v_mfma_f32_32x32x16_bf16 v[48:63], v[124:127], v[120:123], v[48:63]
  v_mfma_f32_32x32x16_bf16 v[64:79], v[128:131], v[120:123], v[64:79]
  s_waitcnt vmcnt(0) lgkmcnt(0)
  v_mfma_f32_32x32x16_bf16 v[48:63], v[132:135], v[80:83], v[48:63]
  v_mfma_f32_32x32x16_bf16 v[64:79], v[136:139], v[80:83], v[64:79]
  v_subrev_u32 v152, 0x10000, v152
  s_cmp_lg_u32 s3, 0
  s_cbranch_scc1 E2_11_R1
  s_nop 7
  ds_write_b128 v148, v[56:59] offset:38976
  ds_write_b128 v148, v[60:63] offset:40000
  ds_write_b128 v148, v[64:67] offset:43072
  ds_write_b128 v148, v[68:71] offset:44096
  ds_write_b128 v148, v[72:75] offset:47168
  ds_write_b128 v148, v[76:79] offset:48192
  s_branch E2_11_RD
E2_11_R1:
  s_cmp_lg_u32 s3, 1
  s_cbranch_scc1 E2_11_R2
  s_nop 5
  ds_write_b128 v148, v[48:51] offset:28736
  ds_write_b128 v148, v[52:55] offset:29760
  ds_write_b128 v148, v[64:67] offset:45120
  ds_write_b128 v148, v[68:71] offset:46144
  ds_write_b128 v148, v[72:75] offset:49216
  ds_write_b128 v148, v[76:79] offset:50240
  v_mov_b32 v48, v56
  v_mov_b32 v49, v57
  v_mov_b32 v50, v58
  v_mov_b32 v51, v59
  v_mov_b32 v52, v60
  v_mov_b32 v53, v61
  v_mov_b32 v54, v62
  v_mov_b32 v55, v63
  s_branch E2_11_RD
E2_11_R2:
  s_cmp_lg_u32 s3, 2
  s_cbranch_scc1 E2_11_R3
  s_nop 3
  ds_write_b128 v148, v[48:51] offset:30784
  ds_write_b128 v148, v[52:55] offset:31808
  ds_write_b128 v148, v[56:59] offset:34880
  ds_write_b128 v148, v[60:63] offset:35904
  ds_write_b128 v148, v[72:75] offset:51264
  ds_write_b128 v148, v[76:79] offset:52288
  v_mov_b32 v48, v64
  v_mov_b32 v49, v65
  v_mov_b32 v50, v66
  v_mov_b32 v51, v67
  v_mov_b32 v52, v68
  v_mov_b32 v53, v69
  v_mov_b32 v54, v70
  v_mov_b32 v55, v71
  s_branch E2_11_RD
E2_11_R3:
  s_nop 3
  ds_write_b128 v148, v[48:51] offset:32832
  ds_write_b128 v148, v[52:55] offset:33856
  ds_write_b128 v148, v[56:59] offset:36928
  ds_write_b128 v148, v[60:63] offset:37952
  ds_write_b128 v148, v[64:67] offset:41024
  ds_write_b128 v148, v[68:71] offset:42048
  v_mov_b32 v48, v72
  v_mov_b32 v49, v73
  v_mov_b32 v50, v74
  v_mov_b32 v51, v75
  v_mov_b32 v52, v76
  v_mov_b32 v53, v77
  v_mov_b32 v54, v78
  v_mov_b32 v55, v79
E2_11_RD:
  s_waitcnt lgkmcnt(0)
  s_barrier
  ds_read_b128 v[56:59], v153 offset:28736
  ds_read_b128 v[60:63], v153 offset:29760
  ds_read_b128 v[64:67], v153 offset:30784
  ds_read_b128 v[68:71], v153 offset:31808
  ds_read_b128 v[72:75], v153 offset:32832
  ds_read_b128 v[76:79], v153 offset:33856
  s_waitcnt lgkmcnt(4)
  v_pk_add_f32 v[48:49], v[48:49], v[56:57]
  v_pk_add_f32 v[50:51], v[50:51], v[58:59]
  v_pk_add_f32 v[52:53], v[52:53], v[60:61]
  v_pk_add_f32 v[54:55], v[54:55], v[62:63]
  s_waitcnt lgkmcnt(2)
  v_pk_add_f32 v[48:49], v[48:49], v[64:65]
  v_pk_add_f32 v[50:51], v[50:51], v[66:67]
  v_pk_add_f32 v[52:53], v[52:53], v[68:69]
  v_pk_add_f32 v[54:55], v[54:55], v[70:71]
  s_waitcnt lgkmcnt(0)
  v_pk_add_f32 v[48:49], v[48:49], v[72:73]
  v_pk_add_f32 v[50:51], v[50:51], v[74:75]
  v_pk_add_f32 v[52:53], v[52:53], v[76:77]
  v_pk_add_f32 v[54:55], v[54:55], v[78:79]
  v_mul_f32 v48, v48, v159
  v_mul_f32 v49, v49, v159
  v_mul_f32 v50, v50, v159
  v_mul_f32 v51, v51, v159
  v_mul_f32 v52, v52, v159
  v_mul_f32 v53, v53, v159
  v_mul_f32 v54, v54, v159
  v_mul_f32 v55, v55, v159
  v_cvt_pk_bf16_f32 v56, v48, v49
  v_cvt_pk_bf16_f32 v57, v50, v51
  v_cvt_pk_bf16_f32 v58, v52, v53
  v_cvt_pk_bf16_f32 v59, v54, v55
  s_nop 0
  v_permlane32_swap_b32 v56, v58
  v_permlane32_swap_b32 v57, v59
  v_lshlrev_b32 v48, 16, v56
  v_and_b32 v49, s64, v56
  v_lshlrev_b32 v50, 16, v57
  v_and_b32 v51, s64, v57
  v_lshlrev_b32 v52, 16, v58
  v_and_b32 v53, s64, v58
  v_lshlrev_b32 v54, 16, v59
  v_and_b32 v55, s64, v59
  v_dot2_f32_bf16 v48, v12, s60, v48
  v_dot2_f32_bf16 v49, v12, s61, v49
  v_dot2_f32_bf16 v50, v13, s60, v50
  v_dot2_f32_bf16 v51, v13, s61, v51
  v_dot2_f32_bf16 v52, v14, s60, v52
  v_dot2_f32_bf16 v53, v14, s61, v53
  v_dot2_f32_bf16 v54, v15, s60, v54
  v_dot2_f32_bf16 v55, v15, s61, v55
  v_cvt_pk_bf16_f32 v76, v48, v49
  v_cvt_pk_bf16_f32 v77, v50, v51
  v_cvt_pk_bf16_f32 v78, v52, v53
  v_cvt_pk_bf16_f32 v79, v54, v55
  s_add_u32 s73, s79, 28672
  buffer_store_dwordx4 v[76:79], v155, s[52:55], s73 offen
MAIN_END:
  s_endpgm
.section .rodata,"a"
.p2align 6
.amdhsa_kernel interleave_layers__ssm_conv_h3__dense_activation_relu__prompt_kernel
  .amdhsa_next_free_vgpr 512
  .amdhsa_next_free_sgpr 102
  .amdhsa_accum_offset 256
  .amdhsa_group_segment_fixed_size 0
  .amdhsa_kernarg_size 96
  .amdhsa_user_sgpr_count 2
  .amdhsa_user_sgpr_kernarg_segment_ptr 1
  .amdhsa_system_sgpr_workgroup_id_x 1
.end_amdhsa_kernel
```
